```python
import torch

def _softmax(x, axis=-1):
    return torch.softmax(x, dim=axis)
def _gelu(x):
    return torch.nn.functional.gelu(x, approximate="tanh")
def _silu(x):
    return torch.nn.functional.silu(x)
def _sigmoid(x):
    return torch.sigmoid(x)
def _layernorm(x, axis=-1, eps=1e-5):
    m = x.mean(dim=axis, keepdim=True)
    v = x.var(dim=axis, keepdim=True, unbiased=False)
    return (x - m) / torch.sqrt(v + eps)
def _scatter_add(tgt, idx, src, axis=0):
    return tgt.clone().index_add_(axis, idx, src)
def _segment_sum(src, seg, n):
    out = torch.zeros((n,) + src.shape[1:], dtype=src.dtype)
    return out.index_add_(0, seg, src)
def _pad(x, pw):
    flat = tuple(v for pair in reversed(pw) for v in pair)
    return torch.nn.functional.pad(x, flat)

kernel_name = 'recurrent_scan__ssm_conv_s4__mixer_channel_mlp__prompt'

def setup_inputs():

    _w = (lambda a: (lambda t: t.to(torch.bfloat16) if t.is_floating_point() else t)(torch.as_tensor(a)))
    def _A_setup():
        B, L, D, N = 1, 2048, 448, 256
        A_re = -(lambda _x: torch.exp(torch.as_tensor(_x)))((lambda *s: torch.randn(*s, dtype=torch.bfloat16) * 3.2)(D, N))
        A_im = torch.pi * (lambda *s: torch.randn(*s, dtype=torch.bfloat16) * 0.2)(D, N)
        B_re = (lambda *s: torch.randn(*s, dtype=torch.bfloat16) * 0.2)(D, N)
        B_im = (lambda *s: torch.randn(*s, dtype=torch.bfloat16) * 0.2)(D, N)
        C_re = (lambda *s: torch.randn(*s, dtype=torch.bfloat16) * 0.2)(D, N)
        C_im = (lambda *s: torch.randn(*s, dtype=torch.bfloat16) * 0.2)(D, N)
        log_dt = (lambda *s: torch.randn(*s, dtype=torch.bfloat16) * 0.2)(D) * 0.5 - 4.0
        Dskip = (lambda *s: torch.randn(*s, dtype=torch.bfloat16) * 0.2)(D)
        return {
            "u": _w((lambda *s: torch.randn(*s, dtype=torch.bfloat16) * 0.05)(B, L, D)),
            "A_re": _w(A_re),
            "A_im": _w(A_im),
            "B_re": _w(B_re),
            "B_im": _w(B_im),
            "C_re": _w(C_re),
            "C_im": _w(C_im),
            "log_dt": _w(log_dt),
            "Dskip": _w(Dskip),
        }
    _A_in = _A_setup()

    def _B_setup():
        B, S, D, F = 1, 2048, 448, 1792
        return {
            "x": _w((lambda *s: torch.randn(*s, dtype=torch.bfloat16) * 0.05)(B, S, D)),
            "w1": _w((lambda *s: torch.randn(*s, dtype=torch.bfloat16) * 3.2)(D, F) * (D ** -0.5)),
            "b1": _w((lambda *s: torch.randn(*s, dtype=torch.bfloat16) * 1.6)(F)),
            "w2": _w((lambda *s: torch.randn(*s, dtype=torch.bfloat16) * 0.1)(F, D) * (F ** -0.5)),
            "b2": _w((lambda *s: torch.randn(*s, dtype=torch.bfloat16) * 0.2)(D)),
        }
    _B_in = _B_setup()

    return {
        "A_u": _A_in["u"],
        "A_A_re": _A_in["A_re"],
        "A_A_im": _A_in["A_im"],
        "A_B_re": _A_in["B_re"],
        "A_B_im": _A_in["B_im"],
        "A_C_re": _A_in["C_re"],
        "A_C_im": _A_in["C_im"],
        "A_log_dt": _A_in["log_dt"],
        "A_Dskip": _A_in["Dskip"],
        "B_x": _B_in["x"],
        "B_w1": _B_in["w1"],
        "B_b1": _B_in["b1"],
        "B_w2": _B_in["w2"],
        "B_b2": _B_in["b2"],
    }

def reference(A_u, A_A_re, A_A_im, A_B_re, A_B_im, A_C_re, A_C_im, A_log_dt, A_Dskip, B_x, B_w1, B_b1, B_w2, B_b2):
    def _A_ref(u, A_re, A_im, B_re, B_im, C_re, C_im, log_dt, Dskip):
        Bsz, L, D = u.shape
        dt = torch.exp(log_dt)[:, None]
        A = A_re + 1j * A_im
        Bc = B_re + 1j * B_im
        Cc = C_re + 1j * C_im
        logdA = dt * A
        dB = dt * Bc
        l = (lambda x, dt: x.to(dt))(torch.arange(L), A_re.dtype)
        P = torch.exp(logdA[:, :, None] * l[None, None, :])
        K = torch.einsum("dn,dnl,dn->dl", Cc, P, dB).real
        L2 = 2 * L
        Kp = _pad(K, ((0, 0), (0, L)))
        up = (lambda x, *d: x.permute(*d))(u, 0, 2, 1)
        up = _pad(up, ((0, 0), (0, 0), (0, L)))
        Kf = (lambda x, axes=(-2,-1): torch.fft.rfft2(x.float(), dim=axes))(Kp[:, None, :], axes=(-2, -1))
        Uf = (lambda x, axes=(-2,-1): torch.fft.rfft2(x.float(), dim=axes))(up[:, :, None, :], axes=(-2, -1))
        Yf = Uf * Kf[None, :, :, :]
        y = (lambda x, s, axes=(-2,-1): torch.fft.irfft2(x, s=s, dim=axes).to(torch.bfloat16))(Yf, (1, L2), axes=(-2, -1))[:, :, 0, :L]
        y = (lambda x, *d: x.permute(*d))(y, 0, 2, 1) + u * Dskip[None, None, :]
        return y

    def _B_ref(x, w1, b1, w2, b2):
        y = _layernorm(x, axis=-1)
        h = _gelu(torch.einsum("bsd,df->bsf", y, w1) + b1)
        return torch.einsum("bsf,fd->bsd", h, w2) + b2

    x = A_u
    xn = _layernorm(x, axis=-1)
    s = _A_ref(xn, A_A_re, A_A_im, A_B_re, A_B_im, A_C_re, A_C_im, A_log_dt, A_Dskip)
    g = _silu(_B_ref(xn, B_w1, B_b1, B_w2, B_b2))
    return x + s * g
```

```asm
; @launch grid=(256,1,1) block=(512,1,1) lds=163840
.amdgcn_target "amdgcn-amd-amdhsa--gfx950"
.text
.globl recurrent_scan__ssm_conv_s4__mixer_channel_mlp__prompt_kernel
.p2align 8
.type recurrent_scan__ssm_conv_s4__mixer_channel_mlp__prompt_kernel,@function
recurrent_scan__ssm_conv_s4__mixer_channel_mlp__prompt_kernel:
    s_cmp_ge_u32 s2, 256
    s_cbranch_scc1 L_end_F
    s_getpc_b64 s[60:61]
L_pc_F:
    s_load_dwordx2 s[4:5], s[0:1], 0
    s_load_dwordx4 s[48:51], s[0:1], 80
    s_load_dwordx4 s[52:55], s[0:1], 96
    s_load_dwordx4 s[56:59], s[0:1], 112
    s_load_dwordx2 s[6:7], s[0:1], 128
    s_load_dwordx8 s[80:87], s[0:1], 8
    s_load_dwordx8 s[88:95], s[0:1], 40
    s_cmp_ge_u32 s2, 32
    s_cbranch_scc1 L_nopf
    v_lshlrev_b32 v2, 7, v0
    v_cmp_gt_u32 vcc, L_end_F-L_pc_F, v2
    s_nop 0
    s_and_saveexec_b64 s[62:63], vcc
    s_cbranch_execz L_nopf2
    global_load_dword v252, v2, s[60:61]
L_nopf2:
    s_mov_b64 exec, s[62:63]
L_nopf:
    v_lshrrev_b32 v1, 6, v0
    s_nop 0
    v_readfirstlane_b32 s3, v1
    v_and_b32 v1, 63, v0
    s_and_b32 s40, s2, 7
    s_lshr_b32 s41, s2, 3
    s_sub_u32 s41, s41, 4
    s_waitcnt lgkmcnt(0)
    s_mov_b32 s8, s4
    s_and_b32 s9, s5, 0xffff
    s_mov_b32 s10, 1835008
    s_mov_b32 s11, 0x00020000
    s_mov_b32 s12, s48
    s_and_b32 s13, s49, 0xffff
    s_mov_b32 s14, 1605632
    s_mov_b32 s15, 0x00020000
    s_mov_b32 s20, s6
    s_and_b32 s21, s7, 0xffff
    s_mov_b32 s22, 268435456
    s_mov_b32 s23, 0x00020000
    s_mov_b32 s16, s52
    s_and_b32 s17, s53, 0xffff
    s_mov_b32 s18, 1605632
    s_mov_b32 s19, 0x00020000
    s_mov_b32 s24, s56
    s_and_b32 s25, s57, 0xffff
    s_mov_b32 s26, 1835008
    s_mov_b32 s27, 0x00020000
    s_mov_b32 s28, s58
    s_and_b32 s29, s59, 0xffff
    s_mov_b32 s30, 256
    s_mov_b32 s31, 0x00020000
    s_cmp_lt_u32 s2, 32
    s_cbranch_scc1 L_ln
    s_sub_u32 s56, s2, 32
    s_lshr_b32 s57, s3, 2
    s_and_b32 s58, s3, 3
    s_lshl_b32 s60, s56, 10
    v_lshlrev_b32 v24, 1, v0
    v_add_u32 v24, s60, v24
    s_lshl_b32 s60, s56, 1
    s_add_u32 s60, s60, s57
    s_lshl_b32 s60, s60, 1
    v_mov_b32 v25, s60
    global_load_ushort v22, v25, s[92:93]
    global_load_ushort v16, v24, s[80:81]
    global_load_ushort v17, v24, s[82:83]
    global_load_ushort v18, v24, s[84:85]
    global_load_ushort v19, v24, s[86:87]
    global_load_ushort v20, v24, s[88:89]
    global_load_ushort v21, v24, s[90:91]
    global_load_ushort v23, v25, s[94:95]
    s_mul_i32 s60, s41, 37
    s_lshr_b32 s60, s60, 8
    s_mul_i32 s61, s60, 7
    s_sub_u32 s61, s41, s61
    s_lshr_b32 s42, s40, 1
    s_lshl_b32 s42, s42, 2
    s_add_u32 s42, s42, s60
    s_and_b32 s43, s40, 1
    s_mul_i32 s43, s43, 7
    s_add_u32 s43, s43, s61
    s_add_u32 s44, s60, s61
    s_cmp_ge_u32 s44, 7
    s_cselect_b32 s62, 7, 0
    s_sub_u32 s44, s44, s62
    s_and_b32 s45, s3, 3
    s_lshr_b32 s46, s3, 2
    v_lshrrev_b32 v5, 3, v1
    s_lshl_b32 s60, s42, 7
    s_lshl_b32 s61, s3, 4
    s_add_u32 s60, s60, s61
    v_add_u32 v6, s60, v5
    v_mul_u32_u24 v6, 896, v6
    v_lshrrev_b32 v7, 4, v1
    v_xor_b32 v7, v7, v1
    v_and_b32 v7, 7, v7
    v_lshl_add_u32 v2, v7, 4, v6
    v_xor_b32 v7, 4, v7
    v_lshl_add_u32 v3, v7, 4, v6
    v_add_u32 v3, 7168, v3
    s_lshl_b32 s61, s3, 3
    v_add_u32 v6, s61, v5
    v_mul_u32_u24 v6, 3584, v6
    v_lshrrev_b32 v7, 2, v1
    v_and_b32 v7, 4, v7
    v_xor_b32 v7, v7, v1
    v_and_b32 v7, 7, v7
    v_lshl_add_u32 v4, v7, 4, v6
    s_lshl_b32 s61, s43, 8
    v_add_u32 v4, s61, v4
    s_lshl_b32 s37, s3, 11
    s_add_u32 s37, s37, 81920
    s_lshl_b32 s38, s3, 10
    s_add_u32 s38, s38, 16384
    s_lshl_b32 s47, s44, 7
    s_barrier
    s_add_u32 m0, s37, 32768
    s_nop 0
    buffer_load_dwordx4 v2, s[8:11], s47 offen lds
    s_add_u32 m0, s37, 33792
    s_nop 0
    buffer_load_dwordx4 v3, s[8:11], s47 offen lds
    s_mul_i32 s36, s47, 1792
    s_add_u32 m0, s38, 0
    s_nop 0
    buffer_load_dwordx4 v4, s[12:15], s36 offen lds
    s_add_u32 s47, s47, 128
    s_cmp_eq_u32 s47, 896
    s_cselect_b32 s47, 0, s47
    s_mov_b32 s32, s50
    s_and_b32 s33, s51, 0xffff
    s_mov_b32 s34, 3584
    s_mov_b32 s35, 0x00020000
    v_and_b32 v5, 31, v1
    s_lshl_b32 s60, s43, 7
    s_lshl_b32 s61, s46, 5
    s_add_u32 s60, s60, s61
    v_add_lshl_u32 v6, v5, s60, 1
    buffer_load_ushort v14, v6, s[32:35], 0 offen
    buffer_load_ushort v15, v6, s[32:35], 0 offen offset:128
    s_lshl_b32 s60, s42, 2
    s_add_u32 s60, s60, s45
    s_mul_i32 s60, s60, 112
    s_lshl_b32 s61, s43, 3
    s_add_u32 s60, s60, s61
    s_lshl_b32 s61, s46, 1
    s_add_u32 s60, s60, s61
    s_lshl_b32 s60, s60, 10
    v_lshlrev_b32 v13, 4, v1
    v_add_u32 v13, s60, v13
    s_xor_b32 s63, s45, s46
    v_lshrrev_b32 v10, 5, v1
    v_bfe_u32 v11, v1, 1, 3
    v_xor_b32 v11, v11, v10
    s_lshl_b32 s60, s63, 1
    v_xor_b32 v11, s60, v11
    v_lshlrev_b32 v11, 4, v11
    s_lshl_b32 s60, s45, 12
    s_add_u32 s60, s60, 81920
    v_lshl_add_u32 v11, v5, 7, v11
    v_add_u32 v5, s60, v11
    v_xor_b32 v6, 32, v5
    v_xor_b32 v7, 64, v5
    v_xor_b32 v8, 96, v5
    v_bfe_u32 v11, v1, 2, 2
    v_lshl_add_u32 v12, v10, 3, v11
    v_lshlrev_b32 v12, 7, v12
    v_lshrrev_b32 v11, 1, v11
    v_xor_b32 v11, s46, v11
    v_lshl_add_u32 v12, v11, 6, v12
    v_bfe_u32 v11, v1, 4, 1
    v_lshl_add_u32 v12, v11, 5, v12
    v_and_b32 v11, 3, v1
    v_lshl_add_u32 v12, v11, 3, v12
    s_lshl_b32 s60, s63, 11
    s_add_u32 s60, s60, 16384
    v_add_u32 v9, s60, v12
    v_xor_b32 v10, 2048, v9
    v_xor_b32 v11, 4096, v9
    v_xor_b32 v12, 6144, v9
    v_lshrrev_b32 v208, 2, v1
    v_and_b32 v208, 4, v208
    v_xor_b32 v208, v208, v1
    v_and_b32 v208, 7, v208
    v_cmp_eq_u32 vcc, 0, v208
    v_mov_b32 v209, 0x3f803f80
    s_nop 0
    v_cndmask_b32 v200, 0, v209, vcc
    v_mov_b32 v201, v200
    v_mov_b32 v202, v200
    v_mov_b32 v203, v200
    v_mov_b32 v204, 0
    v_mov_b32 v205, 0
    v_mov_b32 v206, 0
    v_mov_b32 v207, 0
    v_mov_b32 v214, 0
    v_mov_b32 v218, 0
    v_mov_b32 v215, 0
    v_mov_b32 v219, 0
    s_lshl_b32 s60, s3, 9
    v_lshlrev_b32 v223, 3, v1
    v_add_u32 v223, s60, v223
    s_mul_i32 s60, s41, 37
    s_lshr_b32 s60, s60, 8
    s_mul_i32 s61, s60, 7
    s_sub_u32 s99, s41, s61
    s_and_b32 s61, s40, 1
    s_lshl_b32 s98, s42, 1
    s_add_u32 s98, s98, s61
    s_lshl_b32 s61, s60, 1
    s_add_u32 s100, s99, s61
    s_lshl_b32 s100, s100, 1
    s_cmp_ge_u32 s100, 14
    s_cselect_b32 s62, 14, 0
    s_sub_u32 s100, s100, s62
    s_lshr_b32 s60, s3, 1
    s_and_b32 s61, s3, 1
    s_lshl_b32 s61, s61, 3
    v_lshrrev_b32 v253, 3, v1
    v_add_u32 v253, s61, v253
    v_mul_u32_u24 v253, 896, v253
    v_lshrrev_b32 v254, 2, v1
    v_and_b32 v254, 4, v254
    v_xor_b32 v254, v254, v1
    v_and_b32 v254, 7, v254
    v_lshl_add_u32 v253, v254, 4, v253
    s_lshl_b32 s61, s99, 7
    v_add_u32 v253, s61, v253
    s_lshl_b32 s101, s3, 10
    v_bfe_u32 v255, v1, 2, 2
    v_lshrrev_b32 v254, 5, v1
    v_lshl_add_u32 v254, v254, 2, v255
    v_lshlrev_b32 v254, 7, v254
    v_lshrrev_b32 v255, 1, v255
    v_lshl_add_u32 v254, v255, 6, v254
    v_bfe_u32 v255, v1, 4, 1
    v_lshl_add_u32 v254, v255, 5, v254
    v_and_b32 v255, 3, v1
    v_lshl_add_u32 v254, v255, 3, v254
    s_lshl_b32 s60, s60, 11
    v_add_u32 v254, s60, v254
    v_xor_b32 v255, 64, v254
    s_mul_i32 m0, s3, 8704
    v_and_b32 v61, 31, v1
    v_mul_u32_u24 v61, 272, v61
    v_lshrrev_b32 v60, 5, v1
    v_lshl_add_u32 v61, v60, 4, v61
    v_add_u32 v61, m0, v61
    v_mov_b32 v60, 0x3f80
    ds_write_addtid_b32 v60 offset:40960
    v_mov_b32 v54, 0x3fb8aa3b
    v_mov_b32 v56, 0x32a57060
    s_waitcnt vmcnt(12)
    v_lshlrev_b32 v22, 16, v22
    v_mul_f32 v55, v22, v54
    v_fma_f32 v54, v22, v54, -v55
    v_fmac_f32 v54, v22, v56
    v_exp_f32 v55, v55
    s_waitcnt vmcnt(11)
    v_lshlrev_b32 v16, 16, v16
    s_waitcnt vmcnt(10)
    v_lshlrev_b32 v17, 16, v17
    s_waitcnt vmcnt(9)
    v_lshlrev_b32 v18, 16, v18
    s_waitcnt vmcnt(8)
    v_lshlrev_b32 v19, 16, v19
    s_waitcnt vmcnt(7)
    v_lshlrev_b32 v20, 16, v20
    s_waitcnt vmcnt(6)
    v_lshlrev_b32 v21, 16, v21
    v_mul_f32 v54, 0x3f317218, v54
    v_fma_f32 v55, v55, v54, v55
    v_cvt_pk_bf16_f32 v56, v55, v55
    v_lshlrev_b32 v56, 16, v56
    v_mul_f32 v16, v16, v56
    v_mul_f32 v17, v17, v56
    v_mul_f32 v18, v18, v56
    v_mul_f32 v19, v19, v56
    v_mul_f32 v16, 0x3fb8aa3b, v16
    v_mul_f32 v17, 0x3e22f983, v17
    v_mul_f32 v58, 0x43800000, v16
    v_mul_f32 v59, 0x43800000, v17
    v_exp_f32 v16, v16
    v_fract_f32 v17, v17
    v_exp_f32 v58, v58
    v_fract_f32 v59, v59
    s_waitcnt vmcnt(5)
    v_lshlrev_b32 v62, 16, v23
    v_cos_f32 v24, v17
    v_sin_f32 v25, v17
    v_cos_f32 v40, v59
    v_sin_f32 v41, v59
    v_pk_mul_f32 v[100:101], v[18:19], v[20:21] op_sel:[1,1] op_sel_hi:[1,0]
    v_pk_fma_f32 v[108:109], v[18:19], v[20:21], v[100:101] op_sel:[0,0,0] op_sel_hi:[0,1,1] neg_lo:[0,0,1]
    v_mul_f32 v24, v24, v16
    v_mul_f32 v25, v25, v16
    v_mul_f32 v40, v40, v58
    v_mul_f32 v41, v41, v58
    v_pk_mul_f32 v[100:101], v[24:25], v[24:25] op_sel:[1,1] op_sel_hi:[1,0]
    v_pk_mul_f32 v[102:103], v[40:41], v[40:41] op_sel:[1,1] op_sel_hi:[1,0]
    v_pk_fma_f32 v[26:27], v[24:25], v[24:25], v[100:101] op_sel:[0,0,0] op_sel_hi:[0,1,1] neg_lo:[0,0,1]
    v_pk_fma_f32 v[42:43], v[40:41], v[40:41], v[102:103] op_sel:[0,0,0] op_sel_hi:[0,1,1] neg_lo:[0,0,1]
    v_cvt_pk_bf16_f32 v54, v24, -v25
    ds_write_addtid_b32 v54 offset:41232
    v_cvt_pk_bf16_f32 v55, v40, -v41
    ds_write_addtid_b32 v55 offset:42048
    ds_write_addtid_b32 v55 offset:42320
    v_pk_mul_f32 v[100:101], v[26:27], v[26:27] op_sel:[1,1] op_sel_hi:[1,0]
    v_pk_mul_f32 v[102:103], v[42:43], v[42:43] op_sel:[1,1] op_sel_hi:[1,0]
    v_pk_mul_f32 v[104:105], v[26:27], v[24:25] op_sel:[1,1] op_sel_hi:[1,0]
    v_pk_mul_f32 v[106:107], v[42:43], v[40:41] op_sel:[1,1] op_sel_hi:[1,0]
    v_pk_fma_f32 v[30:31], v[26:27], v[26:27], v[100:101] op_sel:[0,0,0] op_sel_hi:[0,1,1] neg_lo:[0,0,1]
    v_pk_fma_f32 v[46:47], v[42:43], v[42:43], v[102:103] op_sel:[0,0,0] op_sel_hi:[0,1,1] neg_lo:[0,0,1]
    v_pk_fma_f32 v[28:29], v[26:27], v[24:25], v[104:105] op_sel:[0,0,0] op_sel_hi:[0,1,1] neg_lo:[0,0,1]
    v_pk_fma_f32 v[44:45], v[42:43], v[40:41], v[106:107] op_sel:[0,0,0] op_sel_hi:[0,1,1] neg_lo:[0,0,1]
    v_cvt_pk_bf16_f32 v56, v26, -v27
    ds_write_addtid_b32 v56 offset:41504
    v_cvt_pk_bf16_f32 v57, v42, -v43
    ds_write_addtid_b32 v57 offset:45584
    v_pk_mul_f32 v[100:101], v[30:31], v[30:31] op_sel:[1,1] op_sel_hi:[1,0]
    v_pk_mul_f32 v[102:103], v[46:47], v[40:41] op_sel:[1,1] op_sel_hi:[1,0]
    v_pk_mul_f32 v[104:105], v[30:31], v[24:25] op_sel:[1,1] op_sel_hi:[1,0]
    v_pk_mul_f32 v[106:107], v[46:47], v[42:43] op_sel:[1,1] op_sel_hi:[1,0]
    v_pk_fma_f32 v[38:39], v[30:31], v[30:31], v[100:101] op_sel:[0,0,0] op_sel_hi:[0,1,1] neg_lo:[0,0,1]
    v_pk_fma_f32 v[48:49], v[46:47], v[40:41], v[102:103] op_sel:[0,0,0] op_sel_hi:[0,1,1] neg_lo:[0,0,1]
    v_pk_fma_f32 v[32:33], v[30:31], v[24:25], v[104:105] op_sel:[0,0,0] op_sel_hi:[0,1,1] neg_lo:[0,0,1]
    v_pk_fma_f32 v[50:51], v[46:47], v[42:43], v[106:107] op_sel:[0,0,0] op_sel_hi:[0,1,1] neg_lo:[0,0,1]
    v_cvt_pk_bf16_f32 v58, v30, -v31
    ds_write_addtid_b32 v58 offset:43136
    v_cvt_pk_bf16_f32 v59, v46, -v47
    ds_write_addtid_b32 v59 offset:47488
    v_cvt_pk_bf16_f32 v54, v28, -v29
    ds_write_addtid_b32 v54 offset:41776
    v_cvt_pk_bf16_f32 v55, v44, -v45
    ds_write_addtid_b32 v55 offset:46672
    v_pk_mul_f32 v[100:101], v[38:39], v[38:39] op_sel:[1,1] op_sel_hi:[1,0]
    v_pk_mul_f32 v[102:103], v[30:31], v[26:27] op_sel:[1,1] op_sel_hi:[1,0]
    v_pk_mul_f32 v[104:105], v[46:47], v[44:45] op_sel:[1,1] op_sel_hi:[1,0]
    v_pk_mul_f32 v[106:107], v[30:31], v[28:29] op_sel:[1,1] op_sel_hi:[1,0]
    v_pk_fma_f32 v[124:125], v[38:39], v[38:39], v[100:101] op_sel:[0,0,0] op_sel_hi:[0,1,1] neg_lo:[0,0,1]
    v_pk_fma_f32 v[34:35], v[30:31], v[26:27], v[102:103] op_sel:[0,0,0] op_sel_hi:[0,1,1] neg_lo:[0,0,1]
    v_pk_fma_f32 v[52:53], v[46:47], v[44:45], v[104:105] op_sel:[0,0,0] op_sel_hi:[0,1,1] neg_lo:[0,0,1]
    v_pk_fma_f32 v[36:37], v[30:31], v[28:29], v[106:107] op_sel:[0,0,0] op_sel_hi:[0,1,1] neg_lo:[0,0,1]
    v_cvt_pk_bf16_f32 v56, v38, -v39
    ds_write_addtid_b32 v56 offset:45312
    v_cvt_pk_bf16_f32 v57, v48, -v49
    ds_write_addtid_b32 v57 offset:48576
    v_cvt_pk_bf16_f32 v58, v32, -v33
    ds_write_addtid_b32 v58 offset:43408
    v_cvt_pk_bf16_f32 v59, v50, -v51
    ds_write_addtid_b32 v59 offset:48032
    v_pk_mul_f32 v[100:101], v[40:41], v[26:27] op_sel:[1,1] op_sel_hi:[1,0]
    v_pk_mul_f32 v[102:103], v[40:41], v[30:31] op_sel:[1,1] op_sel_hi:[1,0]
    v_pk_mul_f32 v[104:105], v[40:41], v[34:35] op_sel:[1,1] op_sel_hi:[1,0]
    v_pk_mul_f32 v[106:107], v[40:41], v[38:39] op_sel:[1,1] op_sel_hi:[1,0]
    v_pk_fma_f32 v[128:129], v[40:41], v[26:27], v[100:101] op_sel:[0,0,0] op_sel_hi:[0,1,1] neg_lo:[0,0,1]
    v_pk_fma_f32 v[130:131], v[40:41], v[30:31], v[102:103] op_sel:[0,0,0] op_sel_hi:[0,1,1] neg_lo:[0,0,1]
    v_pk_fma_f32 v[132:133], v[40:41], v[34:35], v[104:105] op_sel:[0,0,0] op_sel_hi:[0,1,1] neg_lo:[0,0,1]
    v_pk_fma_f32 v[134:135], v[40:41], v[38:39], v[106:107] op_sel:[0,0,0] op_sel_hi:[0,1,1] neg_lo:[0,0,1]
    v_cvt_pk_bf16_f32 v54, v34, -v35
    ds_write_addtid_b32 v54 offset:43680
    v_cvt_pk_bf16_f32 v55, v52, -v53
    ds_write_addtid_b32 v55 offset:49120
    v_cvt_pk_bf16_f32 v56, v36, -v37
    ds_write_addtid_b32 v56 offset:43952
    s_add_u32 m0, s37, 49152
    s_nop 0
    buffer_load_dwordx4 v2, s[8:11], s47 offen lds
    s_mul_i32 m0, s3, 8704
    v_pk_mul_f32 v[100:101], v[42:43], v[30:31] op_sel:[1,1] op_sel_hi:[1,0]
    v_pk_mul_f32 v[102:103], v[42:43], v[38:39] op_sel:[1,1] op_sel_hi:[1,0]
    v_pk_mul_f32 v[104:105], v[44:45], v[30:31] op_sel:[1,1] op_sel_hi:[1,0]
    v_pk_mul_f32 v[106:107], v[44:45], v[38:39] op_sel:[1,1] op_sel_hi:[1,0]
    v_pk_fma_f32 v[116:117], v[42:43], v[30:31], v[100:101] op_sel:[0,0,0] op_sel_hi:[0,1,1] neg_lo:[0,0,1]
    v_pk_fma_f32 v[118:119], v[42:43], v[38:39], v[102:103] op_sel:[0,0,0] op_sel_hi:[0,1,1] neg_lo:[0,0,1]
    v_pk_fma_f32 v[120:121], v[44:45], v[30:31], v[104:105] op_sel:[0,0,0] op_sel_hi:[0,1,1] neg_lo:[0,0,1]
    v_pk_fma_f32 v[122:123], v[44:45], v[38:39], v[106:107] op_sel:[0,0,0] op_sel_hi:[0,1,1] neg_lo:[0,0,1]
    v_cvt_pk_bf16_f32 v57, v128, -v129
    ds_write_addtid_b32 v57 offset:42592
    v_cvt_pk_bf16_f32 v58, v130, -v131
    ds_write_addtid_b32 v58 offset:42864
    ds_write_addtid_b32 v58 offset:44224
    ds_write_addtid_b32 v58 offset:44496
    v_cvt_pk_bf16_f32 v59, v132, -v133
    ds_write_addtid_b32 v59 offset:44768
    v_cvt_pk_bf16_f32 v54, v134, -v135
    ds_write_addtid_b32 v54 offset:45040
    ds_write_addtid_b32 v54 offset:46400
    v_pk_mul_f32 v[100:101], v[46:47], v[38:39] op_sel:[1,1] op_sel_hi:[1,0]
    v_pk_mul_f32 v[102:103], v[48:49], v[38:39] op_sel:[1,1] op_sel_hi:[1,0]
    v_pk_mul_f32 v[104:105], v[50:51], v[38:39] op_sel:[1,1] op_sel_hi:[1,0]
    v_pk_mul_f32 v[106:107], v[52:53], v[38:39] op_sel:[1,1] op_sel_hi:[1,0]
    v_pk_fma_f32 v[128:129], v[46:47], v[38:39], v[100:101] op_sel:[0,0,0] op_sel_hi:[0,1,1] neg_lo:[0,0,1]
    v_pk_fma_f32 v[130:131], v[48:49], v[38:39], v[102:103] op_sel:[0,0,0] op_sel_hi:[0,1,1] neg_lo:[0,0,1]
    v_pk_fma_f32 v[132:133], v[50:51], v[38:39], v[104:105] op_sel:[0,0,0] op_sel_hi:[0,1,1] neg_lo:[0,0,1]
    v_pk_fma_f32 v[134:135], v[52:53], v[38:39], v[106:107] op_sel:[0,0,0] op_sel_hi:[0,1,1] neg_lo:[0,0,1]
    v_cvt_pk_bf16_f32 v55, v116, -v117
    ds_write_addtid_b32 v55 offset:45856
    v_cvt_pk_bf16_f32 v56, v118, -v119
    ds_write_addtid_b32 v56 offset:46128
    v_cvt_pk_bf16_f32 v57, v120, -v121
    ds_write_addtid_b32 v57 offset:46944
    v_cvt_pk_bf16_f32 v58, v122, -v123
    ds_write_addtid_b32 v58 offset:47216
    v_pk_mul_f32 v[100:101], v[108:109], v[38:39] op_sel:[1,1] op_sel_hi:[1,0]
    v_pk_mul_f32 v[102:103], v[108:109], v[124:125] op_sel:[1,1] op_sel_hi:[1,0]
    v_pk_mul_f32 v[104:105], v[124:125], v[124:125] op_sel:[1,1] op_sel_hi:[1,0]
    v_pk_fma_f32 v[110:111], v[108:109], v[38:39], v[100:101] op_sel:[0,0,0] op_sel_hi:[0,1,1] neg_lo:[0,0,1]
    v_pk_fma_f32 v[112:113], v[108:109], v[124:125], v[102:103] op_sel:[0,0,0] op_sel_hi:[0,1,1] neg_lo:[0,0,1]
    v_pk_fma_f32 v[126:127], v[124:125], v[124:125], v[104:105] op_sel:[0,0,0] op_sel_hi:[0,1,1] neg_lo:[0,0,1]
    v_cvt_pk_bf16_f32 v59, v128, -v129
    ds_write_addtid_b32 v59 offset:47760
    v_cvt_pk_bf16_f32 v54, v130, -v131
    ds_write_addtid_b32 v54 offset:48848
    v_cvt_pk_bf16_f32 v55, v132, -v133
    ds_write_addtid_b32 v55 offset:48304
    v_cvt_pk_bf16_f32 v56, v134, -v135
    ds_write_addtid_b32 v56 offset:49392
    v_pk_mul_f32 v[100:101], v[110:111], v[124:125] op_sel:[1,1] op_sel_hi:[1,0]
    v_pk_fma_f32 v[114:115], v[110:111], v[124:125], v[100:101] op_sel:[0,0,0] op_sel_hi:[0,1,1] neg_lo:[0,0,1]
    ds_read_b128 v[64:67], v61 offset:40960
    ds_read_b128 v[68:71], v61 offset:40992
    ds_read_b128 v[72:75], v61 offset:41024
    ds_read_b128 v[76:79], v61 offset:41056
    ds_read_b128 v[80:83], v61 offset:41088
    ds_read_b128 v[84:87], v61 offset:41120
    ds_read_b128 v[88:91], v61 offset:41152
    ds_read_b128 v[92:95], v61 offset:41184
    v_pk_mul_f32 v[100:101], v[108:109], v[126:127] op_sel:[1,1] op_sel_hi:[1,0]
    v_pk_mul_f32 v[102:103], v[110:111], v[126:127] op_sel:[1,1] op_sel_hi:[1,0]
    v_pk_mul_f32 v[104:105], v[112:113], v[126:127] op_sel:[1,1] op_sel_hi:[1,0]
    v_pk_mul_f32 v[106:107], v[114:115], v[126:127] op_sel:[1,1] op_sel_hi:[1,0]
    v_pk_fma_f32 v[116:117], v[108:109], v[126:127], v[100:101] op_sel:[0,0,0] op_sel_hi:[0,1,1] neg_lo:[0,0,1]
    v_pk_fma_f32 v[118:119], v[110:111], v[126:127], v[102:103] op_sel:[0,0,0] op_sel_hi:[0,1,1] neg_lo:[0,0,1]
    v_pk_fma_f32 v[120:121], v[112:113], v[126:127], v[104:105] op_sel:[0,0,0] op_sel_hi:[0,1,1] neg_lo:[0,0,1]
    v_pk_fma_f32 v[122:123], v[114:115], v[126:127], v[106:107] op_sel:[0,0,0] op_sel_hi:[0,1,1] neg_lo:[0,0,1]
    v_cvt_pk_bf16_f32 v57, v108, v109
    ds_write_addtid_b32 v57 offset:40960
    v_cvt_pk_bf16_f32 v58, v110, v111
    ds_write_addtid_b32 v58 offset:41232
    v_cvt_pk_bf16_f32 v59, v112, v113
    ds_write_addtid_b32 v59 offset:41504
    v_cvt_pk_bf16_f32 v54, v114, v115
    ds_write_addtid_b32 v54 offset:41776
    s_add_u32 m0, s37, 50176
    s_nop 0
    buffer_load_dwordx4 v3, s[8:11], s47 offen lds
    s_mul_i32 m0, s3, 8704
    v_pk_mul_f32 v[100:101], v[116:117], v[126:127] op_sel:[1,1] op_sel_hi:[1,0]
    v_pk_mul_f32 v[102:103], v[118:119], v[126:127] op_sel:[1,1] op_sel_hi:[1,0]
    v_pk_mul_f32 v[104:105], v[120:121], v[126:127] op_sel:[1,1] op_sel_hi:[1,0]
    v_pk_mul_f32 v[106:107], v[122:123], v[126:127] op_sel:[1,1] op_sel_hi:[1,0]
    v_pk_fma_f32 v[108:109], v[116:117], v[126:127], v[100:101] op_sel:[0,0,0] op_sel_hi:[0,1,1] neg_lo:[0,0,1]
    v_pk_fma_f32 v[110:111], v[118:119], v[126:127], v[102:103] op_sel:[0,0,0] op_sel_hi:[0,1,1] neg_lo:[0,0,1]
    v_pk_fma_f32 v[112:113], v[120:121], v[126:127], v[104:105] op_sel:[0,0,0] op_sel_hi:[0,1,1] neg_lo:[0,0,1]
    v_pk_fma_f32 v[114:115], v[122:123], v[126:127], v[106:107] op_sel:[0,0,0] op_sel_hi:[0,1,1] neg_lo:[0,0,1]
    v_cvt_pk_bf16_f32 v55, v116, v117
    ds_write_addtid_b32 v55 offset:42048
    v_cvt_pk_bf16_f32 v56, v118, v119
    ds_write_addtid_b32 v56 offset:42320
    v_cvt_pk_bf16_f32 v57, v120, v121
    ds_write_addtid_b32 v57 offset:42592
    v_cvt_pk_bf16_f32 v58, v122, v123
    ds_write_addtid_b32 v58 offset:42864
    v_pk_mul_f32 v[100:101], v[108:109], v[126:127] op_sel:[1,1] op_sel_hi:[1,0]
    v_pk_mul_f32 v[102:103], v[110:111], v[126:127] op_sel:[1,1] op_sel_hi:[1,0]
    v_pk_mul_f32 v[104:105], v[112:113], v[126:127] op_sel:[1,1] op_sel_hi:[1,0]
    v_pk_mul_f32 v[106:107], v[114:115], v[126:127] op_sel:[1,1] op_sel_hi:[1,0]
    v_pk_fma_f32 v[116:117], v[108:109], v[126:127], v[100:101] op_sel:[0,0,0] op_sel_hi:[0,1,1] neg_lo:[0,0,1]
    v_pk_fma_f32 v[118:119], v[110:111], v[126:127], v[102:103] op_sel:[0,0,0] op_sel_hi:[0,1,1] neg_lo:[0,0,1]
    v_pk_fma_f32 v[120:121], v[112:113], v[126:127], v[104:105] op_sel:[0,0,0] op_sel_hi:[0,1,1] neg_lo:[0,0,1]
    v_pk_fma_f32 v[122:123], v[114:115], v[126:127], v[106:107] op_sel:[0,0,0] op_sel_hi:[0,1,1] neg_lo:[0,0,1]
    v_cvt_pk_bf16_f32 v59, v108, v109
    ds_write_addtid_b32 v59 offset:43136
    v_cvt_pk_bf16_f32 v54, v110, v111
    ds_write_addtid_b32 v54 offset:43408
    v_cvt_pk_bf16_f32 v55, v112, v113
    ds_write_addtid_b32 v55 offset:43680
    v_cvt_pk_bf16_f32 v56, v114, v115
    ds_write_addtid_b32 v56 offset:43952
    s_mul_i32 s36, s47, 1792
    s_add_u32 m0, s38, 8192
    s_nop 0
    buffer_load_dwordx4 v4, s[12:15], s36 offen lds
    s_add_u32 s47, s47, 128
    s_cmp_eq_u32 s47, 896
    s_cselect_b32 s47, 0, s47
    s_mul_i32 m0, s3, 8704
    v_pk_mul_f32 v[100:101], v[116:117], v[126:127] op_sel:[1,1] op_sel_hi:[1,0]
    v_pk_mul_f32 v[102:103], v[118:119], v[126:127] op_sel:[1,1] op_sel_hi:[1,0]
    v_pk_mul_f32 v[104:105], v[120:121], v[126:127] op_sel:[1,1] op_sel_hi:[1,0]
    v_pk_mul_f32 v[106:107], v[122:123], v[126:127] op_sel:[1,1] op_sel_hi:[1,0]
    v_pk_fma_f32 v[108:109], v[116:117], v[126:127], v[100:101] op_sel:[0,0,0] op_sel_hi:[0,1,1] neg_lo:[0,0,1]
    v_pk_fma_f32 v[110:111], v[118:119], v[126:127], v[102:103] op_sel:[0,0,0] op_sel_hi:[0,1,1] neg_lo:[0,0,1]
    v_pk_fma_f32 v[112:113], v[120:121], v[126:127], v[104:105] op_sel:[0,0,0] op_sel_hi:[0,1,1] neg_lo:[0,0,1]
    v_pk_fma_f32 v[114:115], v[122:123], v[126:127], v[106:107] op_sel:[0,0,0] op_sel_hi:[0,1,1] neg_lo:[0,0,1]
    v_cvt_pk_bf16_f32 v57, v116, v117
    ds_write_addtid_b32 v57 offset:44224
    v_cvt_pk_bf16_f32 v58, v118, v119
    ds_write_addtid_b32 v58 offset:44496
    v_cvt_pk_bf16_f32 v59, v120, v121
    ds_write_addtid_b32 v59 offset:44768
    v_cvt_pk_bf16_f32 v54, v122, v123
    ds_write_addtid_b32 v54 offset:45040
    v_pk_mul_f32 v[100:101], v[108:109], v[126:127] op_sel:[1,1] op_sel_hi:[1,0]
    v_pk_mul_f32 v[102:103], v[110:111], v[126:127] op_sel:[1,1] op_sel_hi:[1,0]
    v_pk_mul_f32 v[104:105], v[112:113], v[126:127] op_sel:[1,1] op_sel_hi:[1,0]
    v_pk_mul_f32 v[106:107], v[114:115], v[126:127] op_sel:[1,1] op_sel_hi:[1,0]
    v_pk_fma_f32 v[116:117], v[108:109], v[126:127], v[100:101] op_sel:[0,0,0] op_sel_hi:[0,1,1] neg_lo:[0,0,1]
    v_pk_fma_f32 v[118:119], v[110:111], v[126:127], v[102:103] op_sel:[0,0,0] op_sel_hi:[0,1,1] neg_lo:[0,0,1]
    v_pk_fma_f32 v[120:121], v[112:113], v[126:127], v[104:105] op_sel:[0,0,0] op_sel_hi:[0,1,1] neg_lo:[0,0,1]
    v_pk_fma_f32 v[122:123], v[114:115], v[126:127], v[106:107] op_sel:[0,0,0] op_sel_hi:[0,1,1] neg_lo:[0,0,1]
    v_cvt_pk_bf16_f32 v55, v108, v109
    ds_write_addtid_b32 v55 offset:45312
    v_cvt_pk_bf16_f32 v56, v110, v111
    ds_write_addtid_b32 v56 offset:45584
    v_cvt_pk_bf16_f32 v57, v112, v113
    ds_write_addtid_b32 v57 offset:45856
    v_cvt_pk_bf16_f32 v58, v114, v115
    ds_write_addtid_b32 v58 offset:46128
    s_add_u32 m0, s37, 65536
    s_nop 0
    buffer_load_dwordx4 v2, s[8:11], s47 offen lds
    s_mul_i32 m0, s3, 8704
    v_pk_mul_f32 v[100:101], v[116:117], v[126:127] op_sel:[1,1] op_sel_hi:[1,0]
    v_pk_mul_f32 v[102:103], v[118:119], v[126:127] op_sel:[1,1] op_sel_hi:[1,0]
    v_pk_mul_f32 v[104:105], v[120:121], v[126:127] op_sel:[1,1] op_sel_hi:[1,0]
    v_pk_mul_f32 v[106:107], v[122:123], v[126:127] op_sel:[1,1] op_sel_hi:[1,0]
    v_pk_fma_f32 v[108:109], v[116:117], v[126:127], v[100:101] op_sel:[0,0,0] op_sel_hi:[0,1,1] neg_lo:[0,0,1]
    v_pk_fma_f32 v[110:111], v[118:119], v[126:127], v[102:103] op_sel:[0,0,0] op_sel_hi:[0,1,1] neg_lo:[0,0,1]
    v_pk_fma_f32 v[112:113], v[120:121], v[126:127], v[104:105] op_sel:[0,0,0] op_sel_hi:[0,1,1] neg_lo:[0,0,1]
    v_pk_fma_f32 v[114:115], v[122:123], v[126:127], v[106:107] op_sel:[0,0,0] op_sel_hi:[0,1,1] neg_lo:[0,0,1]
    v_cvt_pk_bf16_f32 v59, v116, v117
    ds_write_addtid_b32 v59 offset:46400
    v_cvt_pk_bf16_f32 v54, v118, v119
    ds_write_addtid_b32 v54 offset:46672
    v_cvt_pk_bf16_f32 v55, v120, v121
    ds_write_addtid_b32 v55 offset:46944
    v_cvt_pk_bf16_f32 v56, v122, v123
    ds_write_addtid_b32 v56 offset:47216
    v_pk_mul_f32 v[100:101], v[108:109], v[126:127] op_sel:[1,1] op_sel_hi:[1,0]
    v_pk_mul_f32 v[102:103], v[110:111], v[126:127] op_sel:[1,1] op_sel_hi:[1,0]
    v_pk_mul_f32 v[104:105], v[112:113], v[126:127] op_sel:[1,1] op_sel_hi:[1,0]
    v_pk_mul_f32 v[106:107], v[114:115], v[126:127] op_sel:[1,1] op_sel_hi:[1,0]
    v_pk_fma_f32 v[116:117], v[108:109], v[126:127], v[100:101] op_sel:[0,0,0] op_sel_hi:[0,1,1] neg_lo:[0,0,1]
    v_pk_fma_f32 v[118:119], v[110:111], v[126:127], v[102:103] op_sel:[0,0,0] op_sel_hi:[0,1,1] neg_lo:[0,0,1]
    v_pk_fma_f32 v[120:121], v[112:113], v[126:127], v[104:105] op_sel:[0,0,0] op_sel_hi:[0,1,1] neg_lo:[0,0,1]
    v_pk_fma_f32 v[122:123], v[114:115], v[126:127], v[106:107] op_sel:[0,0,0] op_sel_hi:[0,1,1] neg_lo:[0,0,1]
    v_cvt_pk_bf16_f32 v57, v108, v109
    ds_write_addtid_b32 v57 offset:47488
    v_cvt_pk_bf16_f32 v58, v110, v111
    ds_write_addtid_b32 v58 offset:47760
    v_cvt_pk_bf16_f32 v59, v112, v113
    ds_write_addtid_b32 v59 offset:48032
    v_cvt_pk_bf16_f32 v54, v114, v115
    ds_write_addtid_b32 v54 offset:48304
    s_add_u32 m0, s37, 66560
    s_nop 0
    buffer_load_dwordx4 v3, s[8:11], s47 offen lds
    s_mul_i32 m0, s3, 8704
    v_cvt_pk_bf16_f32 v55, v116, v117
    ds_write_addtid_b32 v55 offset:48576
    v_cvt_pk_bf16_f32 v56, v118, v119
    ds_write_addtid_b32 v56 offset:48848
    v_cvt_pk_bf16_f32 v57, v120, v121
    ds_write_addtid_b32 v57 offset:49120
    v_cvt_pk_bf16_f32 v58, v122, v123
    ds_write_addtid_b32 v58 offset:49392
    ds_read_b128 v[20:23], v61 offset:40960
    ds_read_b128 v[24:27], v61 offset:40992
    ds_read_b128 v[28:31], v61 offset:41024
    ds_read_b128 v[32:35], v61 offset:41056
    ds_read_b128 v[36:39], v61 offset:41088
    ds_read_b128 v[40:43], v61 offset:41120
    ds_read_b128 v[44:47], v61 offset:41152
    ds_read_b128 v[48:51], v61 offset:41184
    s_mul_i32 s36, s47, 1792
    s_add_u32 m0, s38, 16384
    s_nop 0
    buffer_load_dwordx4 v4, s[12:15], s36 offen lds
    s_add_u32 s47, s47, 128
    s_cmp_eq_u32 s47, 896
    s_cselect_b32 s47, 0, s47
    s_mul_i32 m0, s3, 8704
    s_mul_i32 s60, s57, 34816
    s_add_u32 s60, s60, 40960
    v_lshlrev_b32 v63, 4, v1
    v_add_u32 v60, s60, v63
    v_add_u32 v63, m0, v63
    s_waitcnt lgkmcnt(7)
    v_mfma_f32_32x32x16_bf16 v[108:123], v[64:67], v[20:23], 0
    s_waitcnt lgkmcnt(6)
    v_mfma_f32_32x32x16_bf16 v[108:123], v[68:71], v[24:27], v[108:123]
    s_waitcnt lgkmcnt(5)
    v_mfma_f32_32x32x16_bf16 v[108:123], v[72:75], v[28:31], v[108:123]
    s_waitcnt lgkmcnt(4)
    v_mfma_f32_32x32x16_bf16 v[108:123], v[76:79], v[32:35], v[108:123]
    s_waitcnt lgkmcnt(3)
    v_mfma_f32_32x32x16_bf16 v[108:123], v[80:83], v[36:39], v[108:123]
    s_waitcnt lgkmcnt(2)
    v_mfma_f32_32x32x16_bf16 v[108:123], v[84:87], v[40:43], v[108:123]
    s_waitcnt lgkmcnt(1)
    v_mfma_f32_32x32x16_bf16 v[108:123], v[88:91], v[44:47], v[108:123]
    s_waitcnt lgkmcnt(0)
    v_mfma_f32_32x32x16_bf16 v[108:123], v[92:95], v[48:51], v[108:123]
    v_min_u32 v248, 447, v0
    s_mul_i32 s60, s41, 57344
    v_lshlrev_b32 v249, 7, v248
    buffer_load_dword v247, v249, s[16:19], s60 offen
    s_lshr_b32 s60, s3, 1
    s_mul_i32 s60, s60, 14
    s_add_u32 s61, s100, s60
    s_add_u32 s62, s60, 14
    s_and_b32 s63, s61, -4
    s_add_u32 s63, s63, s61
    s_lshl_b32 s48, s63, 10
    s_add_u32 s61, s61, 1
    s_cmp_eq_u32 s61, s62
    s_cselect_b32 s61, s60, s61
    s_and_b32 s63, s61, -4
    s_add_u32 s63, s63, s61
    s_lshl_b32 s49, s63, 10
    s_add_u32 s61, s61, 1
    s_cmp_eq_u32 s61, s62
    s_cselect_b32 s61, s60, s61
    s_and_b32 s63, s61, -4
    s_add_u32 s63, s63, s61
    s_lshl_b32 s50, s63, 10
    s_add_u32 s61, s61, 1
    s_cmp_eq_u32 s61, s62
    s_cselect_b32 s61, s60, s61
    s_and_b32 s63, s61, -4
    s_add_u32 s63, s63, s61
    s_lshl_b32 s51, s63, 10
    s_add_u32 s61, s61, 1
    s_cmp_eq_u32 s61, s62
    s_cselect_b32 s61, s60, s61
    s_and_b32 s63, s61, -4
    s_add_u32 s63, s63, s61
    s_lshl_b32 s52, s63, 10
    s_add_u32 s61, s61, 1
    s_cmp_eq_u32 s61, s62
    s_cselect_b32 s61, s60, s61
    s_and_b32 s63, s61, -4
    s_add_u32 s63, s63, s61
    s_lshl_b32 s53, s63, 10
    s_add_u32 s61, s61, 1
    s_cmp_eq_u32 s61, s62
    s_cselect_b32 s61, s60, s61
    s_and_b32 s63, s61, -4
    s_add_u32 s63, s63, s61
    s_lshl_b32 s96, s63, 10
    s_add_u32 s61, s61, 1
    s_cmp_eq_u32 s61, s62
    s_cselect_b32 s61, s60, s61
    s_and_b32 s63, s61, -4
    s_add_u32 s63, s63, s61
    s_lshl_b32 s97, s63, 10
    s_add_u32 s61, s61, 1
    s_cmp_eq_u32 s61, s62
    s_cselect_b32 s61, s60, s61
    s_and_b32 s63, s61, -4
    s_add_u32 s63, s63, s61
    s_lshl_b32 s40, s63, 10
    s_add_u32 s61, s61, 1
    s_cmp_eq_u32 s61, s62
    s_cselect_b32 s61, s60, s61
    s_and_b32 s63, s61, -4
    s_add_u32 s63, s63, s61
    s_lshl_b32 s41, s63, 10
    s_add_u32 s61, s61, 1
    s_cmp_eq_u32 s61, s62
    s_cselect_b32 s61, s60, s61
    s_and_b32 s63, s61, -4
    s_add_u32 s63, s63, s61
    s_lshl_b32 s43, s63, 10
    s_add_u32 s61, s61, 1
    s_cmp_eq_u32 s61, s62
    s_cselect_b32 s61, s60, s61
    s_and_b32 s63, s61, -4
    s_add_u32 s63, s63, s61
    s_lshl_b32 s44, s63, 10
    s_add_u32 s61, s61, 1
    s_cmp_eq_u32 s61, s62
    s_cselect_b32 s61, s60, s61
    s_and_b32 s63, s61, -4
    s_add_u32 s63, s63, s61
    s_lshl_b32 s0, s63, 10
    s_add_u32 s61, s61, 1
    s_cmp_eq_u32 s61, s62
    s_cselect_b32 s61, s60, s61
    s_and_b32 s63, s61, -4
    s_add_u32 s63, s63, s61
    s_lshl_b32 s1, s63, 10
    s_mul_i32 s59, s48, 14
    s_add_u32 m0, s101, 8192
    s_nop 0
    buffer_load_dwordx4 v253, s[16:19], s59 offen lds
    ds_write_b128 v63, v[108:111] offset:40960
    ds_write_b128 v63, v[112:115] offset:41984
    ds_write_b128 v63, v[116:119] offset:43008
    ds_write_b128 v63, v[120:123] offset:44032
    s_waitcnt lgkmcnt(0)
    s_barrier
    s_cmp_lg_u32 s58, 0
    s_cbranch_scc1 L_cd
    ds_read_b128 v[64:67], v60 offset:0
    ds_read_b128 v[68:71], v60 offset:8704
    ds_read_b128 v[72:75], v60 offset:17408
    ds_read_b128 v[76:79], v60 offset:26112
    ds_read_b128 v[80:83], v60 offset:1024
    ds_read_b128 v[84:87], v60 offset:9728
    ds_read_b128 v[88:91], v60 offset:18432
    ds_read_b128 v[92:95], v60 offset:27136
    ds_read_b128 v[96:99], v60 offset:2048
    ds_read_b128 v[100:103], v60 offset:10752
    ds_read_b128 v[104:107], v60 offset:19456
    ds_read_b128 v[108:111], v60 offset:28160
    s_waitcnt lgkmcnt(10)
    v_add_f32 v64, v64, v68
    s_waitcnt lgkmcnt(8)
    v_add_f32 v72, v72, v76
    v_add_f32 v65, v65, v69
    v_add_f32 v73, v73, v77
    v_add_f32 v66, v66, v70
    v_add_f32 v74, v74, v78
    v_add_f32 v67, v67, v71
    v_add_f32 v75, v75, v79
    v_add_f32 v16, v64, v72
    v_add_f32 v17, v65, v73
    v_add_f32 v18, v66, v74
    v_add_f32 v19, v67, v75
    s_waitcnt lgkmcnt(6)
    v_add_f32 v80, v80, v84
    s_waitcnt lgkmcnt(4)
    v_add_f32 v88, v88, v92
    v_add_f32 v81, v81, v85
    v_add_f32 v89, v89, v93
    v_add_f32 v82, v82, v86
    v_add_f32 v90, v90, v94
    v_add_f32 v83, v83, v87
    v_add_f32 v91, v91, v95
    v_add_f32 v20, v80, v88
    v_add_f32 v21, v81, v89
    v_add_f32 v22, v82, v90
    v_add_f32 v23, v83, v91
    s_waitcnt lgkmcnt(2)
    v_add_f32 v96, v96, v100
    s_waitcnt lgkmcnt(0)
    v_add_f32 v104, v104, v108
    v_add_f32 v24, v96, v104
    s_mov_b64 exec, 1
    v_add_f32 v16, v62, v16
    s_mov_b64 exec, -1
    s_branch L_kw
L_cd:
    s_cmp_eq_u32 s58, 1
    s_cselect_b64 s[62:63], -1, 0
    s_cselect_b32 s60, 0, 1024
    v_add_u32 v60, s60, v60
    ds_read_b128 v[64:67], v60 offset:2048
    ds_read_b128 v[68:71], v60 offset:10752
    ds_read_b128 v[72:75], v60 offset:19456
    ds_read_b128 v[76:79], v60 offset:28160
    s_cmp_eq_u32 s58, 3
    s_cselect_b64 vcc, -1, 0
    s_mov_b32 s60, 0xaaaaaaaa
    s_or_b32 s60, s60, s62
    s_mov_b32 s61, s60
    s_waitcnt lgkmcnt(2)
    v_add_f32 v64, v64, v68
    s_waitcnt lgkmcnt(0)
    v_add_f32 v72, v72, v76
    v_add_f32 v65, v65, v69
    v_add_f32 v73, v73, v77
    v_add_f32 v66, v66, v70
    v_add_f32 v74, v74, v78
    v_add_f32 v67, v67, v71
    v_add_f32 v75, v75, v79
    v_add_f32 v64, v64, v72
    v_add_f32 v65, v65, v73
    v_add_f32 v66, v66, v74
    v_add_f32 v22, v67, v75
    v_cndmask_b32 v68, v64, v66, vcc
    v_cndmask_b32 v69, v65, v22, vcc
    v_cndmask_b32 v16, v68, v65, s[62:63]
    v_cndmask_b32 v21, v69, v66, s[62:63]
    v_mov_b32 v17, v16
    v_mov_b32 v18, v16
    v_cndmask_b32 v19, v16, v21, s[62:63]
    v_cndmask_b32 v20, v16, v21, s[60:61]
    v_cndmask_b32 v22, v21, v22, s[62:63]
    v_mov_b32 v23, v22
    v_mov_b32 v24, v22
L_kw:
    s_nop 1
    v_cvt_pk_bf16_f32 v232, v17, v18
    v_cvt_pk_bf16_f32 v233, v19, v20
    v_cvt_pk_bf16_f32 v234, v21, v22
    v_cvt_pk_bf16_f32 v235, v23, v24
    v_cvt_pk_bf16_f32 v236, v16, v17
    v_cvt_pk_bf16_f32 v237, v18, v19
    v_cvt_pk_bf16_f32 v238, v20, v21
    v_cvt_pk_bf16_f32 v239, v22, v23
    s_waitcnt vmcnt(10)
    s_waitcnt lgkmcnt(0)
    s_barrier
    ds_read_b128 v[16:19], v5 offset:32768
    ds_read_b64_tr_b16 v[160:161], v9 offset:0
    ds_read_b64_tr_b16 v[162:163], v9 offset:512
    ds_read_b128 v[20:23], v6 offset:32768
    ds_read_b64_tr_b16 v[164:165], v10 offset:0
    ds_read_b64_tr_b16 v[166:167], v10 offset:512
    ds_read_b128 v[24:27], v7 offset:32768
    ds_read_b64_tr_b16 v[168:169], v11 offset:0
    ds_read_b64_tr_b16 v[170:171], v11 offset:512
    ds_read_b128 v[28:31], v8 offset:32768
    ds_read_b64_tr_b16 v[172:173], v12 offset:0
    ds_read_b64_tr_b16 v[174:175], v12 offset:512
    s_add_u32 m0, s37, 0
    s_nop 0
    buffer_load_dwordx4 v2, s[8:11], s47 offen lds
    s_add_u32 m0, s37, 1024
    s_nop 0
    buffer_load_dwordx4 v3, s[8:11], s47 offen lds
    s_mul_i32 s36, s47, 1792
    s_add_u32 m0, s38, 24576
    s_nop 0
    buffer_load_dwordx4 v4, s[12:15], s36 offen lds
    s_add_u32 s47, s47, 128
    s_cmp_eq_u32 s47, 896
    s_cselect_b32 s47, 0, s47
    s_waitcnt vmcnt(8)
    s_barrier
    s_waitcnt lgkmcnt(9)
    v_mfma_f32_32x32x16_bf16 v[128:143], v[160:163], v[16:19], 0
    ds_read_b128 v[32:35], v5 offset:49152
    ds_read_b64_tr_b16 v[176:177], v9 offset:8192
    s_lshr_b32 s60, s3, 1
    s_and_b32 s60, s60, 1
    s_and_b32 s61, s3, 1
    s_mul_i32 s62, s60, 16640
    s_lshl_b32 s63, s61, 7
    s_add_u32 s62, s62, s63
    v_and_b32 v208, 3, v1
    v_bfe_u32 v209, v1, 2, 1
    v_lshl_add_u32 v210, v208, 1, v209
    v_mfma_f32_16x16x32_bf16 v[192:195], v[200:203], v[160:163], 0
    ds_read_b64_tr_b16 v[178:179], v9 offset:8704
    s_add_u32 m0, s37, 16384
    s_nop 0
    buffer_load_dwordx4 v2, s[8:11], s47 offen lds
    v_mul_u32_u24 v248, 2080, v210
    v_mfma_f32_4x4x4_16b_bf16 v[204:207], v[16:17], v[16:17], v[204:207]
    ds_read_b128 v[36:39], v6 offset:49152
    v_xor_b32 v210, 1, v210
    s_waitcnt lgkmcnt(10)
    v_mfma_f32_32x32x16_bf16 v[128:143], v[164:167], v[20:23], v[128:143]
    ds_read_b64_tr_b16 v[180:181], v10 offset:8192
    v_mul_u32_u24 v249, 2080, v210
    v_lshrrev_b32 v208, 4, v1
    v_bfe_u32 v209, v1, 2, 2
    v_lshl_add_u32 v210, v208, 1, v209
    v_mfma_f32_16x16x32_bf16 v[196:199], v[200:203], v[16:19], 0
    ds_read_b64_tr_b16 v[182:183], v10 offset:8704
    s_add_u32 m0, s37, 17408
    s_nop 0
    buffer_load_dwordx4 v3, s[8:11], s47 offen lds
    v_lshrrev_b32 v209, 1, v210
    v_mfma_f32_4x4x4_16b_bf16 v[204:207], v[18:19], v[18:19], v[204:207]
    ds_read_b128 v[40:43], v7 offset:49152
    v_lshl_add_u32 v248, v209, 3, v248
    s_waitcnt lgkmcnt(10)
    v_mfma_f32_32x32x16_bf16 v[128:143], v[168:171], v[24:27], v[128:143]
    ds_read_b64_tr_b16 v[184:185], v11 offset:8192
    v_add_u32 v210, 1, v210
    v_lshrrev_b32 v209, 1, v210
    v_lshl_add_u32 v249, v209, 3, v249
    v_add_u32 v248, s62, v248
    v_mfma_f32_4x4x4_16b_bf16 v[204:207], v[24:25], v[24:25], v[204:207]
    ds_read_b64_tr_b16 v[186:187], v11 offset:8704
    s_mul_i32 s36, s47, 1792
    s_add_u32 m0, s38, 32768
    s_nop 0
    buffer_load_dwordx4 v4, s[12:15], s36 offen lds
    s_add_u32 s47, s47, 128
    s_cmp_eq_u32 s47, 896
    s_cselect_b32 s47, 0, s47
    v_add_u32 v249, s62, v249
    s_waitcnt lgkmcnt(9)
    v_mfma_f32_32x32x16_bf16 v[128:143], v[172:175], v[28:31], v[128:143]
    ds_read_b128 v[44:47], v8 offset:49152
    s_mul_i32 s62, s60, 4576
    s_lshl_b32 s63, s61, 8
    s_add_u32 s62, s62, s63
    s_add_u32 s62, s62, 25056
    v_and_b32 v209, 15, v1
    v_lshlrev_b32 v209, 5, v209
    v_lshlrev_b32 v250, 4, v208
    v_mfma_f32_16x16x32_bf16 v[196:199], v[200:203], v[24:27], v[196:199]
    ds_read_b64_tr_b16 v[188:189], v12 offset:8192
    v_sub_u32 v250, v250, v209
    v_mfma_f32_4x4x4_16b_bf16 v[204:207], v[26:27], v[26:27], v[204:207]
    ds_read_b64_tr_b16 v[190:191], v12 offset:8704
    v_add_u32 v250, s62, v250
    s_waitcnt vmcnt(8)
    s_barrier
    s_waitcnt lgkmcnt(9)
    v_mfma_f32_32x32x16_bf16 v[128:143], v[176:179], v[32:35], v[128:143]
    v_add_u32 v224, 0x10000, v5
    ds_read_b128 v[48:51], v224
    ds_read_b64_tr_b16 v[160:161], v9 offset:16384
    s_mul_i32 s61, s57, 16640
    s_lshl_b32 s62, s58, 9
    s_add_u32 s62, s62, s61
    v_mfma_f32_16x16x32_bf16 v[192:195], v[200:203], v[176:179], v[192:195]
    ds_read_b64_tr_b16 v[162:163], v9 offset:16896
    s_add_u32 m0, s37, 32768
    s_nop 0
    buffer_load_dwordx4 v2, s[8:11], s47 offen lds
    v_lshlrev_b32 v252, 3, v1
    v_mfma_f32_4x4x4_16b_bf16 v[204:207], v[32:33], v[32:33], v[204:207]
    v_add_u32 v225, 0x10000, v6
    ds_read_b128 v[52:55], v225
    s_waitcnt lgkmcnt(10)
    v_mfma_f32_32x32x16_bf16 v[128:143], v[180:183], v[36:39], v[128:143]
    ds_read_b64_tr_b16 v[164:165], v10 offset:16384
    v_add_u32 v252, s62, v252
    v_mfma_f32_16x16x32_bf16 v[196:199], v[200:203], v[32:35], v[196:199]
    ds_read_b64_tr_b16 v[166:167], v10 offset:16896
    s_add_u32 m0, s37, 33792
    s_nop 0
    buffer_load_dwordx4 v3, s[8:11], s47 offen lds
    s_and_b32 s60, s3, 1
    v_mfma_f32_4x4x4_16b_bf16 v[204:207], v[34:35], v[34:35], v[204:207]
    v_add_u32 v226, 0x10000, v7
    ds_read_b128 v[56:59], v226
    s_waitcnt lgkmcnt(10)
    v_mfma_f32_32x32x16_bf16 v[128:143], v[184:187], v[40:43], v[128:143]
    ds_read_b64_tr_b16 v[168:169], v11 offset:16384
    s_lshl_b32 s61, s98, 1
    s_add_u32 s60, s60, s61
    s_mul_i32 s60, s60, 114688
    v_mfma_f32_4x4x4_16b_bf16 v[204:207], v[40:41], v[40:41], v[204:207]
    ds_read_b64_tr_b16 v[170:171], v11 offset:16896
    s_mul_i32 s36, s47, 1792
    s_add_u32 m0, s38, 40960
    s_nop 0
    buffer_load_dwordx4 v4, s[12:15], s36 offen lds
    s_add_u32 s47, s47, 128
    s_cmp_eq_u32 s47, 896
    s_cselect_b32 s47, 0, s47
    s_waitcnt lgkmcnt(9)
    v_mfma_f32_32x32x16_bf16 v[128:143], v[188:191], v[44:47], v[128:143]
    v_add_u32 v227, 0x10000, v8
    ds_read_b128 v[60:63], v227
    v_lshlrev_b32 v251, 4, v1
    v_mfma_f32_16x16x32_bf16 v[196:199], v[200:203], v[40:43], v[196:199]
    ds_read_b64_tr_b16 v[172:173], v12 offset:16384
    v_add_u32 v251, s60, v251
    v_mfma_f32_4x4x4_16b_bf16 v[204:207], v[42:43], v[42:43], v[204:207]
    ds_read_b64_tr_b16 v[174:175], v12 offset:16896
    s_waitcnt vmcnt(6)
    s_barrier
    s_waitcnt lgkmcnt(9)
    v_mfma_f32_32x32x16_bf16 v[128:143], v[160:163], v[48:51], v[128:143]
    ds_read_b128 v[64:67], v5 offset:0
    ds_read_b64_tr_b16 v[176:177], v9 offset:24576
    v_mfma_f32_16x16x32_bf16 v[192:195], v[200:203], v[160:163], v[192:195]
    ds_read_b64_tr_b16 v[178:179], v9 offset:25088
    s_add_u32 m0, s37, 49152
    s_nop 0
    buffer_load_dwordx4 v2, s[8:11], s47 offen lds
    v_mfma_f32_4x4x4_16b_bf16 v[204:207], v[48:49], v[48:49], v[204:207]
    ds_read_b128 v[68:71], v6 offset:0
    s_waitcnt lgkmcnt(10)
    v_mfma_f32_32x32x16_bf16 v[128:143], v[164:167], v[52:55], v[128:143]
    ds_read_b64_tr_b16 v[180:181], v10 offset:24576
    v_mfma_f32_16x16x32_bf16 v[196:199], v[200:203], v[48:51], v[196:199]
    ds_read_b64_tr_b16 v[182:183], v10 offset:25088
    s_add_u32 m0, s37, 50176
    s_nop 0
    buffer_load_dwordx4 v3, s[8:11], s47 offen lds
    v_mfma_f32_4x4x4_16b_bf16 v[204:207], v[50:51], v[50:51], v[204:207]
    ds_read_b128 v[72:75], v7 offset:0
    s_waitcnt lgkmcnt(10)
    v_mfma_f32_32x32x16_bf16 v[128:143], v[168:171], v[56:59], v[128:143]
    ds_read_b64_tr_b16 v[184:185], v11 offset:24576
    v_mfma_f32_4x4x4_16b_bf16 v[204:207], v[56:57], v[56:57], v[204:207]
    ds_read_b64_tr_b16 v[186:187], v11 offset:25088
    s_mul_i32 s36, s47, 1792
    s_add_u32 m0, s38, 49152
    s_nop 0
    buffer_load_dwordx4 v4, s[12:15], s36 offen lds
    s_add_u32 s47, s47, 128
    s_cmp_eq_u32 s47, 896
    s_cselect_b32 s47, 0, s47
    s_waitcnt lgkmcnt(9)
    v_mfma_f32_32x32x16_bf16 v[128:143], v[172:175], v[60:63], v[128:143]
    ds_read_b128 v[76:79], v8 offset:0
    v_mfma_f32_16x16x32_bf16 v[196:199], v[200:203], v[56:59], v[196:199]
    ds_read_b64_tr_b16 v[188:189], v12 offset:24576
    v_mfma_f32_4x4x4_16b_bf16 v[204:207], v[58:59], v[58:59], v[204:207]
    ds_read_b64_tr_b16 v[190:191], v12 offset:25088
    s_waitcnt vmcnt(6)
    s_barrier
    s_waitcnt lgkmcnt(9)
    v_mfma_f32_32x32x16_bf16 v[128:143], v[176:179], v[64:67], v[128:143]
    ds_read_b128 v[80:83], v5 offset:16384
    ds_read_b64_tr_b16 v[160:161], v9 offset:32768
    v_mfma_f32_16x16x32_bf16 v[192:195], v[200:203], v[176:179], v[192:195]
    ds_read_b64_tr_b16 v[162:163], v9 offset:33280
    s_mul_i32 s36, s47, 1792
    s_add_u32 s36, s36, 128
    s_add_u32 m0, s38, 57344
    s_nop 0
    buffer_load_dwordx4 v4, s[12:15], s36 offen lds
    s_add_u32 s47, s47, 128
    s_cmp_eq_u32 s47, 896
    s_cselect_b32 s47, 0, s47
    v_mfma_f32_4x4x4_16b_bf16 v[204:207], v[64:65], v[64:65], v[204:207]
    ds_read_b128 v[84:87], v6 offset:16384
    s_waitcnt lgkmcnt(10)
    v_mfma_f32_32x32x16_bf16 v[128:143], v[180:183], v[68:71], v[128:143]
    ds_read_b64_tr_b16 v[164:165], v10 offset:32768
    v_mfma_f32_16x16x32_bf16 v[196:199], v[200:203], v[64:67], v[196:199]
    ds_read_b64_tr_b16 v[166:167], v10 offset:33280
    s_mul_i32 s36, s47, 1792
    s_add_u32 s36, s36, 128
    s_add_u32 m0, s38, 0
    s_nop 0
    buffer_load_dwordx4 v4, s[12:15], s36 offen lds
    s_add_u32 s47, s47, 128
    s_cmp_eq_u32 s47, 896
    s_cselect_b32 s47, 0, s47
    s_cmp_lg_u32 s3, 0
    s_cbranch_scc1 L_w0_p1
    buffer_load_dword v3, off, s[28:31], 0 sc1
L_w0_p1:
    v_mfma_f32_4x4x4_16b_bf16 v[204:207], v[66:67], v[66:67], v[204:207]
    ds_read_b128 v[88:91], v7 offset:16384
    s_waitcnt lgkmcnt(10)
    v_mfma_f32_32x32x16_bf16 v[128:143], v[184:187], v[72:75], v[128:143]
    ds_read_b64_tr_b16 v[168:169], v11 offset:32768
    v_mfma_f32_4x4x4_16b_bf16 v[204:207], v[72:73], v[72:73], v[204:207]
    ds_read_b64_tr_b16 v[170:171], v11 offset:33280
    s_mul_i32 s59, s49, 14
    s_add_u32 m0, s101, 147456
    s_nop 0
    buffer_load_dwordx4 v253, s[16:19], s59 offen lds
    s_waitcnt lgkmcnt(9)
    v_mfma_f32_32x32x16_bf16 v[128:143], v[188:191], v[76:79], v[128:143]
    ds_read_b128 v[92:95], v8 offset:16384
    v_mfma_f32_16x16x32_bf16 v[196:199], v[200:203], v[72:75], v[196:199]
    ds_read_b64_tr_b16 v[172:173], v12 offset:32768
    v_mfma_f32_4x4x4_16b_bf16 v[204:207], v[74:75], v[74:75], v[204:207]
    ds_read_b64_tr_b16 v[174:175], v12 offset:33280
    s_waitcnt vmcnt(6)
    s_barrier
    s_waitcnt lgkmcnt(9)
    v_mfma_f32_32x32x16_bf16 v[128:143], v[160:163], v[80:83], v[128:143]
    ds_read_b128 v[96:99], v5 offset:32768
    ds_read_b64_tr_b16 v[176:177], v9 offset:40960
    v_mfma_f32_16x16x32_bf16 v[192:195], v[200:203], v[160:163], v[192:195]
    ds_read_b64_tr_b16 v[178:179], v9 offset:41472
    s_mul_i32 s36, s47, 1792
    s_add_u32 s36, s36, 128
    s_add_u32 m0, s38, 8192
    s_nop 0
    buffer_load_dwordx4 v4, s[12:15], s36 offen lds
    s_add_u32 s47, s47, 128
    s_cmp_eq_u32 s47, 896
    s_cselect_b32 s47, 0, s47
    v_mfma_f32_4x4x4_16b_bf16 v[204:207], v[80:81], v[80:81], v[204:207]
    ds_read_b128 v[100:103], v6 offset:32768
    s_waitcnt lgkmcnt(10)
    v_mfma_f32_32x32x16_bf16 v[128:143], v[164:167], v[84:87], v[128:143]
    ds_read_b64_tr_b16 v[180:181], v10 offset:40960
    v_mfma_f32_16x16x32_bf16 v[196:199], v[200:203], v[80:83], v[196:199]
    ds_read_b64_tr_b16 v[182:183], v10 offset:41472
    s_mul_i32 s36, s47, 1792
    s_add_u32 s36, s36, 128
    s_add_u32 m0, s38, 16384
    s_nop 0
    buffer_load_dwordx4 v4, s[12:15], s36 offen lds
    s_add_u32 s47, s47, 128
    s_cmp_eq_u32 s47, 896
    s_cselect_b32 s47, 0, s47
    v_mfma_f32_4x4x4_16b_bf16 v[204:207], v[82:83], v[82:83], v[204:207]
    ds_read_b128 v[104:107], v7 offset:32768
    s_waitcnt lgkmcnt(10)
    v_mfma_f32_32x32x16_bf16 v[128:143], v[168:171], v[88:91], v[128:143]
    ds_read_b64_tr_b16 v[184:185], v11 offset:40960
    v_mfma_f32_4x4x4_16b_bf16 v[204:207], v[88:89], v[88:89], v[204:207]
    ds_read_b64_tr_b16 v[186:187], v11 offset:41472
    s_mul_i32 s59, s50, 14
    s_add_u32 m0, s101, 155648
    s_nop 0
    buffer_load_dwordx4 v253, s[16:19], s59 offen lds
    s_waitcnt lgkmcnt(9)
    v_mfma_f32_32x32x16_bf16 v[128:143], v[172:175], v[92:95], v[128:143]
    ds_read_b128 v[108:111], v8 offset:32768
    v_mfma_f32_16x16x32_bf16 v[196:199], v[200:203], v[88:91], v[196:199]
    ds_read_b64_tr_b16 v[188:189], v12 offset:40960
    v_mfma_f32_4x4x4_16b_bf16 v[204:207], v[90:91], v[90:91], v[204:207]
    ds_read_b64_tr_b16 v[190:191], v12 offset:41472
    s_waitcnt vmcnt(6)
    s_barrier
    s_waitcnt lgkmcnt(9)
    v_mfma_f32_32x32x16_bf16 v[128:143], v[176:179], v[96:99], v[128:143]
    ds_read_b128 v[112:115], v5 offset:49152
    ds_read_b64_tr_b16 v[160:161], v9 offset:49152
    v_mfma_f32_16x16x32_bf16 v[192:195], v[200:203], v[176:179], v[192:195]
    ds_read_b64_tr_b16 v[162:163], v9 offset:49664
    s_mul_i32 s36, s47, 1792
    s_add_u32 s36, s36, 128
    s_add_u32 m0, s38, 24576
    s_nop 0
    buffer_load_dwordx4 v4, s[12:15], s36 offen lds
    s_add_u32 s47, s47, 128
    s_cmp_eq_u32 s47, 896
    s_cselect_b32 s47, 0, s47
    v_mfma_f32_4x4x4_16b_bf16 v[204:207], v[96:97], v[96:97], v[204:207]
    ds_read_b128 v[116:119], v6 offset:49152
    s_waitcnt lgkmcnt(10)
    v_mfma_f32_32x32x16_bf16 v[128:143], v[180:183], v[100:103], v[128:143]
    ds_read_b64_tr_b16 v[164:165], v10 offset:49152
    v_mfma_f32_16x16x32_bf16 v[196:199], v[200:203], v[96:99], v[196:199]
    ds_read_b64_tr_b16 v[166:167], v10 offset:49664
    s_mul_i32 s36, s47, 1792
    s_add_u32 s36, s36, 128
    s_add_u32 m0, s38, 32768
    s_nop 0
    buffer_load_dwordx4 v4, s[12:15], s36 offen lds
    s_add_u32 s47, s47, 128
    s_cmp_eq_u32 s47, 896
    s_cselect_b32 s47, 0, s47
    s_cmp_lg_u32 s3, 0
    s_cbranch_scc1 L_w0_p2
    s_waitcnt vmcnt(6)
    v_readfirstlane_b32 s62, v3
    s_nop 0
    s_cmp_ge_u32 s62, 1
    s_cbranch_scc1 L_pd_i1
    s_mov_b32 s63, 0
L_pl_i1:
    buffer_load_dword v3, off, s[28:31], 0 sc1
    s_waitcnt vmcnt(0)
    v_readfirstlane_b32 s62, v3
    s_nop 0
    s_cmp_ge_u32 s62, 1
    s_cbranch_scc1 L_pd_i1
    s_add_u32 s63, s63, 1
    s_cmp_lt_u32 s63, 20000
    s_cbranch_scc1 L_pl_i1
L_pd_i1:
    s_mov_b32 s39, s62
    v_mov_b32 v210, 0
    v_mov_b32 v211, s62
    ds_write_b32 v210, v211 offset:4100
L_w0_p2:
    v_mfma_f32_4x4x4_16b_bf16 v[204:207], v[98:99], v[98:99], v[204:207]
    ds_read_b128 v[120:123], v7 offset:49152
    s_waitcnt lgkmcnt(10)
    v_mfma_f32_32x32x16_bf16 v[128:143], v[184:187], v[104:107], v[128:143]
    ds_read_b64_tr_b16 v[168:169], v11 offset:49152
    v_mfma_f32_4x4x4_16b_bf16 v[204:207], v[104:105], v[104:105], v[204:207]
    ds_read_b64_tr_b16 v[170:171], v11 offset:49664
    s_mul_i32 s59, s51, 14
    s_add_u32 m0, s101, 81920
    s_nop 0
    buffer_load_dwordx4 v253, s[16:19], s59 offen lds
    s_waitcnt lgkmcnt(9)
    v_mfma_f32_32x32x16_bf16 v[128:143], v[188:191], v[108:111], v[128:143]
    ds_read_b128 v[124:127], v8 offset:49152
    v_mfma_f32_16x16x32_bf16 v[196:199], v[200:203], v[104:107], v[196:199]
    ds_read_b64_tr_b16 v[172:173], v12 offset:49152
    v_mfma_f32_4x4x4_16b_bf16 v[204:207], v[106:107], v[106:107], v[204:207]
    ds_read_b64_tr_b16 v[174:175], v12 offset:49664
    s_waitcnt vmcnt(8)
    s_barrier
    s_waitcnt lgkmcnt(9)
    v_mfma_f32_32x32x16_bf16 v[128:143], v[160:163], v[112:115], v[128:143]
    ds_read_b64_tr_b16 v[176:177], v9 offset:57344
    v_mfma_f32_16x16x32_bf16 v[192:195], v[200:203], v[160:163], v[192:195]
    ds_read_b64_tr_b16 v[178:179], v9 offset:57856
    s_mul_i32 s36, s47, 1792
    s_add_u32 s36, s36, 128
    s_add_u32 m0, s38, 40960
    s_nop 0
    buffer_load_dwordx4 v4, s[12:15], s36 offen lds
    s_add_u32 s47, s47, 128
    s_cmp_eq_u32 s47, 896
    s_cselect_b32 s47, 0, s47
    v_mfma_f32_4x4x4_16b_bf16 v[204:207], v[112:113], v[112:113], v[204:207]
    ds_read_b64_tr_b16 v[180:181], v10 offset:57344
    s_waitcnt lgkmcnt(9)
    v_mfma_f32_32x32x16_bf16 v[128:143], v[164:167], v[116:119], v[128:143]
    ds_read_b64_tr_b16 v[182:183], v10 offset:57856
    v_mfma_f32_16x16x32_bf16 v[196:199], v[200:203], v[112:115], v[196:199]
    ds_read_b64_tr_b16 v[184:185], v11 offset:57344
    s_mul_i32 s59, s52, 14
    s_add_u32 m0, s101, 90112
    s_nop 0
    buffer_load_dwordx4 v253, s[16:19], s59 offen lds
    v_mov_b32 v5, v254
    v_mov_b32 v6, v255
    v_add_u32 v7, 0x10000, v254
    v_add_u32 v8, 0x10000, v255
    v_add_u32 v2, 57344, v253
    v_mfma_f32_4x4x4_16b_bf16 v[204:207], v[114:115], v[114:115], v[204:207]
    ds_read_b64_tr_b16 v[186:187], v11 offset:57856
    s_waitcnt lgkmcnt(9)
    v_mfma_f32_32x32x16_bf16 v[128:143], v[168:171], v[120:123], v[128:143]
    ds_read_b64_tr_b16 v[188:189], v12 offset:57344
    v_mfma_f32_4x4x4_16b_bf16 v[204:207], v[120:121], v[120:121], v[204:207]
    ds_read_b64_tr_b16 v[190:191], v12 offset:57856
    s_mul_i32 s59, s53, 14
    s_add_u32 m0, s101, 98304
    s_nop 0
    buffer_load_dwordx4 v253, s[16:19], s59 offen lds
    s_waitcnt lgkmcnt(8)
    v_mfma_f32_32x32x16_bf16 v[128:143], v[172:175], v[124:127], v[128:143]
    v_mfma_f32_16x16x32_bf16 v[196:199], v[200:203], v[120:123], v[196:199]
    v_mfma_f32_4x4x4_16b_bf16 v[204:207], v[122:123], v[122:123], v[204:207]
    s_mov_b32 s60, 0xaaaaaaaa
    s_mov_b32 s61, s60
    s_mov_b32 s62, 0xcccccccc
    s_mov_b32 s63, s62
    ds_write_b32 v223, v192 offset:4096
    v_cndmask_b32 v204, v204, v205, s[60:61]
    v_cndmask_b32 v206, v206, v207, s[60:61]
    v_cndmask_b32 v197, v204, v206, s[62:63]
    ds_write_b64 v223, v[196:197] offset:0
    s_cmp_lg_u32 s3, 0
    s_cbranch_scc1 L_w0_p4
    s_mov_b32 s61, 12582912
    buffer_load_dword v3, off, s[20:23], s61 sc1
L_w0_p4:
    s_waitcnt vmcnt(8)
    s_waitcnt lgkmcnt(0)
    s_barrier
    v_and_b32 v206, 31, v1
    s_lshl_b32 s60, s45, 9
    v_lshlrev_b32 v206, 3, v206
    v_add_u32 v206, s60, v206
    s_lshl_b32 s60, s46, 11
    v_lshlrev_b32 v207, 3, v1
    v_add_u32 v207, s60, v207
    ds_read_b64 v[224:225], v206 offset:0
    ds_read_b64 v[226:227], v206 offset:256
    ds_read_b64 v[228:229], v206 offset:2048
    ds_read_b64 v[230:231], v206 offset:2304
    ds_read_b32 v196, v207 offset:4096
    ds_read_b32 v197, v207 offset:4608
    ds_read_b32 v198, v207 offset:5120
    ds_read_b32 v199, v207 offset:5632
    v_mov_b32 v211, 0
    ds_read_b32 v211, v211 offset:4100
    v_mfma_f32_32x32x16_bf16 v[144:159], v[176:179], v[16:19], 0
    ds_read_b64_tr_b16 v[160:161], v9 offset:0
    ds_read_b64_tr_b16 v[162:163], v9 offset:512
    s_waitcnt lgkmcnt(9)
    v_add_f32 v225, v225, v227
    s_waitcnt lgkmcnt(7)
    v_add_f32 v229, v229, v231
    v_add_f32 v224, v224, v228
    v_add_f32 v225, v225, v229
    v_mul_f32 v224, 0xbb124925, v224
    v_mul_f32 v225, 0x3b124925, v225
    v_fma_f32 v225, -v224, v224, v225
    v_max_f32 v225, 0, v225
    v_mfma_f32_16x16x32_bf16 v[192:195], v[200:203], v[176:179], 0
    ds_read_b64_tr_b16 v[164:165], v10 offset:0
    ds_read_b64_tr_b16 v[166:167], v10 offset:512
    s_mul_i32 s59, s96, 14
    s_add_u32 m0, s101, 106496
    s_nop 0
    buffer_load_dwordx4 v253, s[16:19], s59 offen lds
    v_cvt_pk_bf16_f32 v226, v225, v225
    v_lshlrev_b32 v226, 16, v226
    v_mfma_f32_32x32x16_bf16 v[144:159], v[180:183], v[20:23], v[144:159]
    ds_read_b64_tr_b16 v[168:169], v11 offset:0
    ds_read_b64_tr_b16 v[170:171], v11 offset:512
    s_mul_i32 s59, s97, 14
    s_add_u32 m0, s101, 114688
    s_nop 0
    buffer_load_dwordx4 v253, s[16:19], s59 offen lds
    v_add_f32 v226, 0x3727c5ac, v226
    v_cvt_pk_bf16_f32 v226, v226, v226
    v_lshlrev_b32 v226, 16, v226
    v_sqrt_f32 v226, v226
    v_cmp_gt_u32 vcc, 32, v1
    v_cvt_pk_bf16_f32 v226, v226, v226
    v_lshlrev_b32 v226, 16, v226
    v_mfma_f32_32x32x16_bf16 v[144:159], v[184:187], v[24:27], v[144:159]
    ds_read_b64_tr_b16 v[172:173], v12 offset:0
    s_mul_i32 s59, s40, 14
    s_add_u32 m0, s101, 122880
    s_nop 0
    buffer_load_dwordx4 v253, s[16:19], s59 offen lds
    v_rcp_f32 v227, v226
    v_cvt_pk_bf16_f32 v228, v224, v224
    v_mul_f32 v225, v225, v227
    v_mul_f32 v225, v225, v227
    v_cvt_pk_bf16_f32 v225, v225, v225
    v_lshlrev_b32 v225, 16, v225
    v_mfma_f32_32x32x16_bf16 v[144:159], v[188:191], v[28:31], v[144:159]
    ds_read_b64_tr_b16 v[174:175], v12 offset:512
    v_add_f32 v225, 0x3727c5ac, v225
    v_cvt_pk_bf16_f32 v225, v225, v225
    v_lshlrev_b32 v225, 16, v225
    v_sqrt_f32 v225, v225
    v_lshlrev_b32 v229, 16, v228
    v_cvt_pk_bf16_f32 v225, v225, v225
    v_lshlrev_b32 v225, 16, v225
    v_add_u32 v204, 0x20000, v254
    v_add_u32 v205, 0x20000, v255
    s_waitcnt lgkmcnt(6)
    v_mfma_f32_32x32x16_bf16 v[144:159], v[160:163], v[32:35], v[144:159]
    ds_read_b64_tr_b16 v[16:17], v5 offset:8192
    ds_read_b64_tr_b16 v[18:19], v5 offset:9216
    ds_read_b64_tr_b16 v[20:21], v6 offset:8192
    ds_read_b64_tr_b16 v[22:23], v6 offset:9216
    v_readfirstlane_b32 s39, v211
    s_nop 0
    s_bfe_u32 s45, s39, 0x10001
    s_xor_b32 s46, s45, 1
    v_mul_f32 v222, v225, v226
    v_rcp_f32 v227, v222
    v_sub_f32 v229, v224, v229
    v_cvt_pk_bf16_f32 v230, v222, v222
    v_mfma_f32_16x16x32_bf16 v[192:195], v[200:203], v[160:163], v[192:195]
    ds_read_b64_tr_b16 v[24:25], v204 offset:16384
    ds_read_b64_tr_b16 v[26:27], v204 offset:17408
    ds_read_b64_tr_b16 v[28:29], v205 offset:16384
    s_mul_i32 s59, s41, 14
    s_add_u32 m0, s101, 65536
    s_nop 0
    buffer_load_dwordx4 v253, s[16:19], s59 offen lds
    v_lshlrev_b32 v230, 16, v230
    v_sub_f32 v231, v222, v230
    s_waitcnt lgkmcnt(11)
    v_mfma_f32_32x32x16_bf16 v[144:159], v[164:167], v[36:39], v[144:159]
    ds_read_b64_tr_b16 v[30:31], v205 offset:17408
    ds_read_b64_tr_b16 v[176:177], v9 offset:8192
    ds_read_b64_tr_b16 v[178:179], v9 offset:8704
    s_mul_i32 s59, s43, 14
    s_add_u32 m0, s101, 139264
    s_nop 0
    buffer_load_dwordx4 v253, s[16:19], s59 offen lds
    v_cndmask_b32 v216, 0, v228, vcc
    v_cndmask_b32 v229, 0, v229, vcc
    v_cndmask_b32 v230, v231, v230, vcc
    v_cvt_pk_bf16_f32 v217, v229, v230
    v_add_f32 v196, v196, v197
    v_add_f32 v198, v198, v199
    s_waitcnt lgkmcnt(12)
    v_mfma_f32_32x32x16_bf16 v[144:159], v[168:171], v[40:43], v[144:159]
    ds_read_b64_tr_b16 v[180:181], v10 offset:8192
    ds_read_b64_tr_b16 v[182:183], v10 offset:8704
    ds_read_b64_tr_b16 v[184:185], v11 offset:8192
    s_mul_i32 s59, s44, 14
    s_add_u32 m0, s101, 131072
    s_nop 0
    buffer_load_dwordx4 v253, s[16:19], s59 offen lds
    v_add_f32 v196, v196, v198
    v_cvt_pk_bf16_f32 v208, v196, v196
    v_lshlrev_b32 v209, 16, v208
    v_sub_f32 v209, v196, v209
    v_cvt_pk_bf16_f32 v212, v196, v209
    v_and_b32 v208, 0xffff, v208
    v_lshl_or_b32 v213, v14, 16, v208
    s_waitcnt lgkmcnt(13)
    v_mfma_f32_32x32x16_bf16 v[144:159], v[172:175], v[44:47], v[144:159]
    ds_read_b64_tr_b16 v[186:187], v11 offset:8704
    ds_read_b64_tr_b16 v[188:189], v12 offset:8192
    ds_read_b64_tr_b16 v[190:191], v12 offset:8704
    v_mfma_f32_32x32x16_bf16 v[128:143], v[212:215], v[216:219], v[128:143]
    v_mul_f32 v220, 0xc0135761, v227
    v_mul_f32 v221, v227, v227
    v_mul_f32 v221, v221, v227
    v_mul_f32 v221, 0xbdd2d3e8, v221
    s_waitcnt vmcnt(9)
    s_waitcnt lgkmcnt(8)
    s_barrier
    s_waitcnt lgkmcnt(6)
    v_mfma_f32_32x32x16_bf16 v[144:159], v[176:179], v[48:51], v[144:159]
    ds_read_b64_tr_b16 v[32:33], v204 offset:24576
    ds_read_b64_tr_b16 v[34:35], v204 offset:25600
    ds_read_b64_tr_b16 v[36:37], v205 offset:24576
    ds_read_b64_tr_b16 v[38:39], v205 offset:25600
    v_mul_f32 v224, v128, v128
    v_mul_f32 v225, v129, v129
    v_fma_f32 v224, v224, v221, v220
    v_fma_f32 v225, v225, v221, v220
    v_mul_f32 v224, v128, v224
    v_mul_f32 v225, v129, v225
    v_exp_f32 v224, v224
    v_mul_f32 v226, v130, v130
    v_mul_f32 v227, v131, v131
    v_exp_f32 v225, v225
    v_fma_f32 v226, v226, v221, v220
    v_mfma_f32_16x16x32_bf16 v[192:195], v[200:203], v[176:179], v[192:195]
    ds_read_b64_tr_b16 v[40:41], v7 offset:16384
    ds_read_b64_tr_b16 v[42:43], v7 offset:17408
    ds_read_b64_tr_b16 v[44:45], v8 offset:16384
    s_mul_i32 s59, s0, 14
    s_add_u32 m0, s101, 73728
    s_nop 0
    buffer_load_dwordx4 v253, s[16:19], s59 offen lds
    v_fma_f32 v227, v227, v221, v220
    v_mul_f32 v226, v130, v226
    v_mul_f32 v227, v131, v227
    v_exp_f32 v226, v226
    s_waitcnt lgkmcnt(11)
    v_mfma_f32_32x32x16_bf16 v[144:159], v[180:183], v[52:55], v[144:159]
    ds_read_b64_tr_b16 v[46:47], v8 offset:17408
    ds_read_b64_tr_b16 v[160:161], v9 offset:16384
    ds_read_b64_tr_b16 v[162:163], v9 offset:16896
    s_mul_i32 s59, s1, 14
    s_add_u32 m0, s101, 16384
    s_nop 0
    buffer_load_dwordx4 v253, s[16:19], s59 offen lds
    v_fma_f32 v224, v224, v222, v222
    v_mul_f32 v228, v132, v132
    v_mul_f32 v229, v133, v133
    v_exp_f32 v227, v227
    v_fma_f32 v225, v225, v222, v222
    v_fma_f32 v228, v228, v221, v220
    v_fma_f32 v229, v229, v221, v220
    v_rcp_f32 v224, v224
    v_mul_f32 v228, v132, v228
    v_rcp_f32 v225, v225
    s_waitcnt lgkmcnt(12)
    v_mfma_f32_32x32x16_bf16 v[144:159], v[184:187], v[56:59], v[144:159]
    ds_read_b64_tr_b16 v[164:165], v10 offset:16384
    ds_read_b64_tr_b16 v[166:167], v10 offset:16896
    ds_read_b64_tr_b16 v[168:169], v11 offset:16384
    s_mul_i32 s59, s48, 14
    s_add_u32 m0, s101, 8192
    s_nop 0
    buffer_load_dwordx4 v2, s[16:19], s59 offen lds
    v_mul_f32 v229, v133, v229
    v_mul_f32 v224, v128, v224
    v_mul_f32 v225, v129, v225
    v_exp_f32 v228, v228
    v_fma_f32 v226, v226, v222, v222
    v_add_u32 v224, 0x10000, v224
    v_cvt_pk_bf16_f32 v240, v225, v225
    v_alignbit_b32 v240, v240, v224, 16
    v_bfi_b32 v240, 1, s45, v240
    v_mul_f32 v230, v134, v134
    v_mul_f32 v231, v135, v135
    s_waitcnt lgkmcnt(13)
    v_mfma_f32_32x32x16_bf16 v[144:159], v[188:191], v[60:63], v[144:159]
    ds_read_b64_tr_b16 v[170:171], v11 offset:16896
    ds_read_b64_tr_b16 v[172:173], v12 offset:16384
    ds_read_b64_tr_b16 v[174:175], v12 offset:16896
    v_exp_f32 v229, v229
    v_fma_f32 v227, v227, v222, v222
    v_fma_f32 v230, v230, v221, v220
    v_fma_f32 v231, v231, v221, v220
    v_rcp_f32 v226, v226
    v_mul_f32 v230, v134, v230
    v_rcp_f32 v227, v227
    v_mul_f32 v231, v135, v231
    v_mul_f32 v226, v130, v226
    v_mul_f32 v227, v131, v227
    s_waitcnt vmcnt(9)
    s_waitcnt lgkmcnt(8)
    s_barrier
    s_waitcnt lgkmcnt(6)
    v_mfma_f32_32x32x16_bf16 v[144:159], v[160:163], v[64:67], v[144:159]
    ds_read_b64_tr_b16 v[48:49], v7 offset:24576
    ds_read_b64_tr_b16 v[50:51], v7 offset:25600
    ds_read_b64_tr_b16 v[52:53], v8 offset:24576
    ds_read_b64_tr_b16 v[54:55], v8 offset:25600
    v_exp_f32 v230, v230
    v_fma_f32 v228, v228, v222, v222
    v_cvt_pk_bf16_f32 v241, v226, v227
    v_mul_f32 v224, v136, v136
    v_mul_f32 v225, v137, v137
    v_exp_f32 v231, v231
    v_fma_f32 v229, v229, v222, v222
    v_fma_f32 v224, v224, v221, v220
    v_fma_f32 v225, v225, v221, v220
    v_rcp_f32 v228, v228
    v_mfma_f32_16x16x32_bf16 v[192:195], v[200:203], v[160:163], v[192:195]
    ds_read_b64_tr_b16 v[56:57], v7 offset:32768
    ds_read_b64_tr_b16 v[58:59], v7 offset:33792
    ds_read_b64_tr_b16 v[60:61], v8 offset:32768
    s_mul_i32 s59, s49, 14
    s_add_u32 m0, s101, 147456
    s_nop 0
    buffer_load_dwordx4 v2, s[16:19], s59 offen lds
    v_mul_f32 v224, v136, v224
    v_rcp_f32 v229, v229
    v_mul_f32 v225, v137, v225
    s_waitcnt lgkmcnt(11)
    v_mfma_f32_32x32x16_bf16 v[144:159], v[164:167], v[68:71], v[144:159]
    ds_read_b64_tr_b16 v[62:63], v8 offset:33792
    ds_read_b64_tr_b16 v[176:177], v9 offset:24576
    ds_read_b64_tr_b16 v[178:179], v9 offset:25088
    s_mul_i32 s59, s50, 14
    s_add_u32 m0, s101, 155648
    s_nop 0
    buffer_load_dwordx4 v2, s[16:19], s59 offen lds
    v_mul_f32 v228, v132, v228
    v_mul_f32 v229, v133, v229
    v_exp_f32 v224, v224
    v_fma_f32 v230, v230, v222, v222
    v_cvt_pk_bf16_f32 v242, v228, v229
    v_mul_f32 v226, v138, v138
    v_mul_f32 v227, v139, v139
    v_exp_f32 v225, v225
    v_fma_f32 v231, v231, v222, v222
    v_fma_f32 v226, v226, v221, v220
    v_fma_f32 v227, v227, v221, v220
    s_waitcnt lgkmcnt(12)
    v_mfma_f32_32x32x16_bf16 v[144:159], v[168:171], v[72:75], v[144:159]
    ds_read_b64_tr_b16 v[180:181], v10 offset:24576
    ds_read_b64_tr_b16 v[182:183], v10 offset:25088
    ds_read_b64_tr_b16 v[184:185], v11 offset:24576
    s_mul_i32 s59, s51, 14
    s_add_u32 m0, s101, 81920
    s_nop 0
    buffer_load_dwordx4 v2, s[16:19], s59 offen lds
    v_rcp_f32 v230, v230
    v_mul_f32 v226, v138, v226
    v_rcp_f32 v231, v231
    v_mul_f32 v227, v139, v227
    v_mul_f32 v230, v134, v230
    v_mul_f32 v231, v135, v231
    v_exp_f32 v226, v226
    v_fma_f32 v224, v224, v222, v222
    v_add_u32 v230, 0x10000, v230
    v_cvt_pk_bf16_f32 v243, v231, v231
    s_waitcnt lgkmcnt(13)
    v_mfma_f32_32x32x16_bf16 v[144:159], v[172:175], v[76:79], v[144:159]
    ds_read_b64_tr_b16 v[186:187], v11 offset:25088
    ds_read_b64_tr_b16 v[188:189], v12 offset:24576
    ds_read_b64_tr_b16 v[190:191], v12 offset:25088
    v_alignbit_b32 v243, v243, v230, 16
    v_bfi_b32 v243, 1, s46, v243
    buffer_store_dwordx4 v[240:243], v13, s[20:23], 0 offen offset:0 sc1
    v_mul_f32 v228, v140, v140
    v_mul_f32 v229, v141, v141
    v_exp_f32 v227, v227
    v_fma_f32 v225, v225, v222, v222
    v_fma_f32 v228, v228, v221, v220
    v_fma_f32 v229, v229, v221, v220
    v_rcp_f32 v224, v224
    s_cmp_lg_u32 s3, 0
    s_cbranch_scc1 L_w0_p3
    s_waitcnt vmcnt(13)
    s_mov_b32 s61, 12582912
    v_readfirstlane_b32 s62, v3
    s_nop 0
    s_cmp_ge_u32 s62, 32
    s_cbranch_scc1 L_pd_ur
    s_mov_b32 s63, 0
L_pl_ur:
    buffer_load_dword v3, off, s[20:23], s61 sc1
    s_waitcnt vmcnt(0)
    v_readfirstlane_b32 s62, v3
    s_nop 0
    s_cmp_ge_u32 s62, 32
    s_cbranch_scc1 L_pd_ur
    s_add_u32 s63, s63, 1
    s_cmp_lt_u32 s63, 20000
    s_cbranch_scc1 L_pl_ur
L_pd_ur:
L_w0_p3:
    s_waitcnt vmcnt(11)
    s_waitcnt lgkmcnt(8)
    s_barrier
    s_waitcnt lgkmcnt(6)
    v_mfma_f32_32x32x16_bf16 v[144:159], v[176:179], v[80:83], v[144:159]
    ds_read_b64_tr_b16 v[64:65], v7 offset:40960
    ds_read_b64_tr_b16 v[66:67], v7 offset:41984
    ds_read_b64_tr_b16 v[68:69], v8 offset:40960
    ds_read_b64_tr_b16 v[70:71], v8 offset:41984
    v_mul_f32 v228, v140, v228
    v_rcp_f32 v225, v225
    v_mul_f32 v229, v141, v229
    v_mul_f32 v224, v136, v224
    v_mul_f32 v225, v137, v225
    v_exp_f32 v228, v228
    v_fma_f32 v226, v226, v222, v222
    v_add_u32 v224, 0x10000, v224
    v_cvt_pk_bf16_f32 v244, v225, v225
    v_alignbit_b32 v244, v244, v224, 16
    v_bfi_b32 v244, 1, s45, v244
    v_mfma_f32_16x16x32_bf16 v[192:195], v[200:203], v[176:179], v[192:195]
    ds_read_b64_tr_b16 v[72:73], v7 offset:49152
    ds_read_b64_tr_b16 v[74:75], v7 offset:50176
    ds_read_b64_tr_b16 v[76:77], v8 offset:49152
    s_mul_i32 s60, s57, 480
    s_add_u32 s60, s60, s101
    s_add_u32 m0, s60, 24576
    s_lshl_b32 s60, s56, 13
    s_add_u32 s60, s60, 8388608
    v_lshlrev_b32 v210, 4, v0
    buffer_load_dwordx4 v210, s[20:23], s60 offen sc1 lds
    v_mul_f32 v230, v142, v142
    v_mul_f32 v231, v143, v143
    v_exp_f32 v229, v229
    s_waitcnt lgkmcnt(11)
    v_mfma_f32_32x32x16_bf16 v[144:159], v[180:183], v[84:87], v[144:159]
    ds_read_b64_tr_b16 v[78:79], v8 offset:50176
    ds_read_b64_tr_b16 v[160:161], v9 offset:32768
    ds_read_b64_tr_b16 v[162:163], v9 offset:33280
    s_mul_i32 s59, s52, 14
    s_add_u32 m0, s101, 90112
    s_nop 0
    buffer_load_dwordx4 v2, s[16:19], s59 offen lds
    v_fma_f32 v227, v227, v222, v222
    v_fma_f32 v230, v230, v221, v220
    v_fma_f32 v231, v231, v221, v220
    v_rcp_f32 v226, v226
    v_mul_f32 v230, v142, v230
    v_rcp_f32 v227, v227
    v_mul_f32 v231, v143, v231
    v_mul_f32 v226, v138, v226
    v_mul_f32 v227, v139, v227
    v_exp_f32 v230, v230
    s_waitcnt lgkmcnt(12)
    v_mfma_f32_32x32x16_bf16 v[144:159], v[184:187], v[88:91], v[144:159]
    ds_read_b64_tr_b16 v[164:165], v10 offset:32768
    ds_read_b64_tr_b16 v[166:167], v10 offset:33280
    ds_read_b64_tr_b16 v[168:169], v11 offset:32768
    s_mul_i32 s59, s53, 14
    s_add_u32 m0, s101, 98304
    s_nop 0
    buffer_load_dwordx4 v2, s[16:19], s59 offen lds
    v_fma_f32 v228, v228, v222, v222
    v_cvt_pk_bf16_f32 v245, v226, v227
    v_exp_f32 v231, v231
    v_fma_f32 v229, v229, v222, v222
    v_rcp_f32 v228, v228
    v_rcp_f32 v229, v229
    v_mul_f32 v228, v140, v228
    v_mul_f32 v229, v141, v229
    v_fma_f32 v230, v230, v222, v222
    v_cvt_pk_bf16_f32 v246, v228, v229
    s_waitcnt lgkmcnt(13)
    v_mfma_f32_32x32x16_bf16 v[144:159], v[188:191], v[92:95], v[144:159]
    ds_read_b64_tr_b16 v[170:171], v11 offset:33280
    ds_read_b64_tr_b16 v[172:173], v12 offset:32768
    ds_read_b64_tr_b16 v[174:175], v12 offset:33280
    v_fma_f32 v231, v231, v222, v222
    v_rcp_f32 v230, v230
    v_rcp_f32 v231, v231
    v_mul_f32 v230, v142, v230
    v_mul_f32 v231, v143, v231
    v_add_u32 v230, 0x10000, v230
    v_cvt_pk_bf16_f32 v247, v231, v231
    v_alignbit_b32 v247, v247, v230, 16
    v_bfi_b32 v247, 1, s46, v247
    buffer_store_dwordx4 v[244:247], v13, s[20:23], 0 offen offset:1024 sc1
    s_waitcnt vmcnt(13)
    s_waitcnt lgkmcnt(8)
    s_barrier
    s_waitcnt lgkmcnt(6)
    v_mfma_f32_32x32x16_bf16 v[144:159], v[160:163], v[96:99], v[144:159]
    ds_read_b64_tr_b16 v[80:81], v7 offset:57344
    ds_read_b64_tr_b16 v[82:83], v7 offset:58368
    ds_read_b64_tr_b16 v[84:85], v8 offset:57344
    ds_read_b64_tr_b16 v[86:87], v8 offset:58368
    v_mfma_f32_16x16x32_bf16 v[192:195], v[200:203], v[160:163], v[192:195]
    ds_read_b64_tr_b16 v[88:89], v7 offset:0
    ds_read_b64_tr_b16 v[90:91], v7 offset:1024
    ds_read_b64_tr_b16 v[92:93], v8 offset:0
    s_mul_i32 s59, s96, 14
    s_add_u32 m0, s101, 106496
    s_nop 0
    buffer_load_dwordx4 v2, s[16:19], s59 offen lds
    s_waitcnt lgkmcnt(11)
    v_mfma_f32_32x32x16_bf16 v[144:159], v[164:167], v[100:103], v[144:159]
    ds_read_b64_tr_b16 v[94:95], v8 offset:1024
    ds_read_b64_tr_b16 v[176:177], v9 offset:40960
    ds_read_b64_tr_b16 v[178:179], v9 offset:41472
    s_waitcnt lgkmcnt(12)
    v_mfma_f32_32x32x16_bf16 v[144:159], v[168:171], v[104:107], v[144:159]
    ds_read_b64_tr_b16 v[180:181], v10 offset:40960
    ds_read_b64_tr_b16 v[182:183], v10 offset:41472
    ds_read_b64_tr_b16 v[184:185], v11 offset:40960
    s_waitcnt lgkmcnt(13)
    v_mfma_f32_32x32x16_bf16 v[144:159], v[172:175], v[108:111], v[144:159]
    ds_read_b64_tr_b16 v[186:187], v11 offset:41472
    ds_read_b64_tr_b16 v[188:189], v12 offset:40960
    ds_read_b64_tr_b16 v[190:191], v12 offset:41472
    s_waitcnt vmcnt(10)
    s_waitcnt lgkmcnt(0)
    s_barrier
    v_mfma_f32_32x32x16_bf16 v[144:159], v[176:179], v[112:115], v[144:159]
    ds_read_b64_tr_b16 v[96:97], v204 offset:8192
    ds_read_b64_tr_b16 v[98:99], v204 offset:9216
    s_cmp_lg_u32 s58, 0
    s_cbranch_scc1 L_nz
    s_mul_i32 s61, s57, 16640
    v_mul_u32_u24 v160, 2080, v1
    v_add_u32 v160, s61, v160
    v_mov_b32 v164, 0
    v_mov_b32 v165, 0
    v_mov_b32 v166, 0
    v_mov_b32 v167, 0
    s_mul_i32 s62, s57, 4576
    v_lshlrev_b32 v161, 4, v1
    v_add_u32 v161, s62, v161
    s_mov_b64 exec, 0xff
    ds_write_b128 v160, v[164:167] offset:33728
    s_mov_b64 exec, 0x3fffffff
    ds_write_b128 v161, v[164:167] offset:28672
    s_mov_b64 exec, 1
    v_mov_b32 v161, 73472
    ds_write_b128 v161, v[164:167] offset:240
    v_lshlrev_b32 v162, 16, v236
    ds_write_b32 v160, v162 offset:35820
    ds_write_b32 v160, v162 offset:44136
    s_mov_b64 exec, -1
L_nz:
    ds_write_b64 v252, v[232:233] offset:33744
    ds_write_b64 v252, v[234:235] offset:35824
    v_add_u32 v169, 39980, v252
    v_mfma_f32_16x16x32_bf16 v[192:195], v[200:203], v[176:179], v[192:195]
    ds_read_b64_tr_b16 v[100:101], v205 offset:8192
    ds_read_b64_tr_b16 v[102:103], v205 offset:9216
    v_mfma_f32_32x32x16_bf16 v[144:159], v[180:183], v[116:119], v[144:159]
    ds_read_b64_tr_b16 v[104:105], v204 offset:0
    ds_read_b64_tr_b16 v[106:107], v204 offset:1024
    v_add_u32 v170, 44140, v252
    v_mov_b32 v174, v233
    v_mov_b32 v175, v234
    v_mfma_f32_32x32x16_bf16 v[144:159], v[184:187], v[120:123], v[144:159]
    ds_read_b64_tr_b16 v[108:109], v205 offset:0
    v_mov_b32 v172, v237
    v_mov_b32 v173, v238
    ds_write_b64 v252, v[236:237] offset:48296
    v_mfma_f32_32x32x16_bf16 v[144:159], v[188:191], v[124:127], v[144:159]
    ds_read_b64_tr_b16 v[110:111], v205 offset:1024
    v_add_u32 v223, 0x10000, v223
    v_add_u32 v207, 0x10000, v207
    ds_write_b32 v223, v192 offset:2048
    ds_read_b64_tr_b16 v[112:113], v7 offset:8192
    ds_read_b64_tr_b16 v[114:115], v7 offset:9216
    ds_read_b64_tr_b16 v[116:117], v8 offset:8192
    ds_read_b64_tr_b16 v[118:119], v8 offset:9216
    ds_read_b64_tr_b16 v[120:121], v5 offset:16384
    ds_read_b64_tr_b16 v[122:123], v5 offset:17408
    ds_read_b64_tr_b16 v[124:125], v6 offset:16384
    ds_read_b64_tr_b16 v[126:127], v6 offset:17408
    ds_write_b64 v252, v[238:239] offset:46224
    ds_write2_b32 v169, v236, v239 offset0:0 offset1:1
    ds_write2_b32 v170, v232, v235 offset0:0 offset1:1
    ds_write_b64 v252, v[172:173] offset:37904
    ds_write_b64 v252, v[174:175] offset:42064
    v_mov_b32 v9, v248
    v_mov_b32 v10, v249
    v_mov_b32 v11, v250
    v_mov_b32 v12, v251
    v_add_u32 v13, 4096, v13
    s_waitcnt vmcnt(4)
    s_waitcnt lgkmcnt(0)
    s_barrier
    ds_read_b32 v196, v207 offset:2048
    ds_read_b32 v197, v207 offset:2560
    ds_read_b32 v198, v207 offset:3072
    ds_read_b32 v199, v207 offset:3584
    s_mov_b32 s47, 0
    s_mov_b32 s36, 0x0c0c0400
    s_bitcmp1_b32 s45, 0
    s_cselect_b32 s37, 1, 0x100
    v_add_u32 v7, 73728, v5
    v_add_u32 v8, 73728, v6
    v_add_u32 v3, 139264, v5
    v_add_u32 v4, 139264, v6
    s_cmp_ge_u32 s3, 4
    s_cbranch_scc1 L_pH
    s_setprio 3
    s_waitcnt lgkmcnt(2)
    v_add_f32 v196, v196, v197
    s_waitcnt lgkmcnt(0)
    v_add_f32 v198, v198, v199
    v_add_f32 v196, v196, v198
    v_cvt_pk_bf16_f32 v208, v196, v196
    v_lshlrev_b32 v209, 16, v208
    v_sub_f32 v209, v196, v209
    v_cvt_pk_bf16_f32 v212, v196, v209
    v_and_b32 v208, 0xffff, v208
    v_lshl_or_b32 v213, v15, 16, v208
    s_nop 1
    v_mfma_f32_32x32x16_bf16 v[144:159], v[212:215], v[216:219], v[144:159]
    s_nop 11
    v_mul_f32 v224, v144, v144
    v_mul_f32 v225, v145, v145
    v_fma_f32 v224, v224, v221, v220
    v_fma_f32 v225, v225, v221, v220
    v_mul_f32 v224, v144, v224
    v_mul_f32 v225, v145, v225
    v_exp_f32 v224, v224
    v_mul_f32 v226, v146, v146
    v_mul_f32 v227, v147, v147
    v_exp_f32 v225, v225
    v_fma_f32 v226, v226, v221, v220
    v_fma_f32 v227, v227, v221, v220
    v_mul_f32 v226, v146, v226
    v_mul_f32 v227, v147, v227
    v_exp_f32 v226, v226
    s_mul_i32 s59, s97, 14
    s_add_u32 m0, s101, 114688
    s_nop 0
    buffer_load_dwordx4 v2, s[16:19], s59 offen lds
    v_fma_f32 v224, v224, v222, v222
    v_mul_f32 v228, v148, v148
    v_mul_f32 v229, v149, v149
    v_exp_f32 v227, v227
    v_fma_f32 v225, v225, v222, v222
    v_fma_f32 v228, v228, v221, v220
    v_fma_f32 v229, v229, v221, v220
    v_rcp_f32 v224, v224
    v_mul_f32 v228, v148, v228
    v_rcp_f32 v225, v225
    v_mul_f32 v229, v149, v229
    v_mul_f32 v224, v144, v224
    v_mul_f32 v225, v145, v225
    v_exp_f32 v228, v228
    v_fma_f32 v226, v226, v222, v222
    v_add_u32 v224, 0x10000, v224
    v_cvt_pk_bf16_f32 v248, v225, v225
    v_alignbit_b32 v248, v248, v224, 16
    v_bfi_b32 v248, 1, s45, v248
    v_mul_f32 v230, v150, v150
    v_mul_f32 v231, v151, v151
    v_exp_f32 v229, v229
    v_fma_f32 v227, v227, v222, v222
    v_fma_f32 v230, v230, v221, v220
    v_fma_f32 v231, v231, v221, v220
    v_rcp_f32 v226, v226
    v_mul_f32 v230, v150, v230
    v_rcp_f32 v227, v227
    v_mul_f32 v231, v151, v231
    v_mul_f32 v226, v146, v226
    s_mul_i32 s59, s40, 14
    s_add_u32 m0, s101, 122880
    s_nop 0
    buffer_load_dwordx4 v2, s[16:19], s59 offen lds
    v_mul_f32 v227, v147, v227
    v_exp_f32 v230, v230
    v_fma_f32 v228, v228, v222, v222
    v_cvt_pk_bf16_f32 v249, v226, v227
    v_mul_f32 v224, v152, v152
    v_mul_f32 v225, v153, v153
    v_exp_f32 v231, v231
    v_fma_f32 v229, v229, v222, v222
    v_fma_f32 v224, v224, v221, v220
    v_fma_f32 v225, v225, v221, v220
    v_rcp_f32 v228, v228
    v_mul_f32 v224, v152, v224
    v_rcp_f32 v229, v229
    v_mul_f32 v225, v153, v225
    v_mul_f32 v228, v148, v228
    v_mul_f32 v229, v149, v229
    v_exp_f32 v224, v224
    v_fma_f32 v230, v230, v222, v222
    v_cvt_pk_bf16_f32 v250, v228, v229
    v_mul_f32 v226, v154, v154
    v_mul_f32 v227, v155, v155
    v_exp_f32 v225, v225
    v_fma_f32 v231, v231, v222, v222
    v_fma_f32 v226, v226, v221, v220
    v_fma_f32 v227, v227, v221, v220
    v_rcp_f32 v230, v230
    v_mul_f32 v226, v154, v226
    v_rcp_f32 v231, v231
    v_mul_f32 v227, v155, v227
    v_mul_f32 v230, v150, v230
    s_mul_i32 s59, s41, 14
    s_add_u32 m0, s101, 131072
    s_nop 0
    buffer_load_dwordx4 v2, s[16:19], s59 offen lds
    v_mul_f32 v231, v151, v231
    v_exp_f32 v226, v226
    v_fma_f32 v224, v224, v222, v222
    v_add_u32 v230, 0x10000, v230
    v_cvt_pk_bf16_f32 v251, v231, v231
    v_alignbit_b32 v251, v251, v230, 16
    v_bfi_b32 v251, 1, s46, v251
    buffer_store_dwordx4 v[248:251], v13, s[20:23], 0 offen offset:0 sc1
    v_mul_f32 v228, v156, v156
    v_mul_f32 v229, v157, v157
    v_exp_f32 v227, v227
    v_fma_f32 v225, v225, v222, v222
    v_fma_f32 v228, v228, v221, v220
    v_fma_f32 v229, v229, v221, v220
    v_rcp_f32 v224, v224
    v_mul_f32 v228, v156, v228
    v_rcp_f32 v225, v225
    v_mul_f32 v229, v157, v229
    v_mul_f32 v224, v152, v224
    v_mul_f32 v225, v153, v225
    v_exp_f32 v228, v228
    v_fma_f32 v226, v226, v222, v222
    v_add_u32 v224, 0x10000, v224
    v_cvt_pk_bf16_f32 v252, v225, v225
    v_alignbit_b32 v252, v252, v224, 16
    v_bfi_b32 v252, 1, s45, v252
    v_mul_f32 v230, v158, v158
    v_mul_f32 v231, v159, v159
    v_exp_f32 v229, v229
    v_fma_f32 v227, v227, v222, v222
    s_mul_i32 s59, s43, 14
    s_add_u32 m0, s101, 139264
    s_nop 0
    buffer_load_dwordx4 v2, s[16:19], s59 offen lds
    v_fma_f32 v230, v230, v221, v220
    v_fma_f32 v231, v231, v221, v220
    ds_read_b64 v[232:233], v9 offset:33728
    v_rcp_f32 v226, v226
    v_mul_f32 v230, v158, v230
    ds_read_b64 v[234:235], v10 offset:33728
    v_rcp_f32 v227, v227
    ds_read_b128 v[184:187], v11 offset:1536
    v_mul_f32 v231, v159, v231
    v_mul_f32 v226, v154, v226
    ds_read_b128 v[188:191], v11 offset:1024
    v_mul_f32 v227, v155, v227
    v_exp_f32 v230, v230
    ds_read_b128 v[192:195], v11 offset:512
    v_fma_f32 v228, v228, v222, v222
    v_cvt_pk_bf16_f32 v253, v226, v227
    ds_read_b128 v[196:199], v11 offset:0
    v_exp_f32 v231, v231
    ds_read_b64 v[236:237], v9 offset:35520
    v_fma_f32 v229, v229, v222, v222
    v_rcp_f32 v228, v228
    ds_read_b64 v[238:239], v10 offset:35520
    v_rcp_f32 v229, v229
    v_mul_f32 v228, v156, v228
    ds_read_b128 v[168:171], v11 offset:3584
    v_mul_f32 v229, v157, v229
    v_fma_f32 v230, v230, v222, v222
    ds_read_b128 v[180:183], v11 offset:2048
    v_cvt_pk_bf16_f32 v254, v228, v229
    ds_read_b128 v[176:179], v11 offset:2560
    v_fma_f32 v231, v231, v222, v222
    v_rcp_f32 v230, v230
    ds_read_b128 v[172:175], v11 offset:3072
    v_rcp_f32 v231, v231
    v_mul_f32 v230, v158, v230
    ds_read_b64 v[240:241], v9 offset:33984
    v_mul_f32 v231, v159, v231
    v_add_u32 v230, 0x10000, v230
    ds_read_b64 v[242:243], v10 offset:33984
    v_cvt_pk_bf16_f32 v255, v231, v231
    ds_read_b64 v[244:245], v9 offset:35264
    v_alignbit_b32 v255, v255, v230, 16
    v_bfi_b32 v255, 1, s46, v255
    ds_read_b64 v[246:247], v10 offset:35264
    buffer_store_dwordx4 v[252:255], v13, s[20:23], 0 offen offset:1024 sc1
    s_setprio 1
    s_waitcnt lgkmcnt(10)
    v_mfma_f32_16x16x32_bf16 v[140:143], v[232:235], v[196:199], 0
    ds_read_b64 v[248:249], v9 offset:34240
    ds_read_b64 v[250:251], v10 offset:34240
    v_mfma_f32_16x16x32_bf16 v[136:139], v[232:235], v[192:195], 0
    v_mfma_f32_16x16x32_bf16 v[132:135], v[232:235], v[188:191], 0
    ds_read_b128 v[216:219], v11 offset:1600
    v_mfma_f32_16x16x32_bf16 v[128:131], v[232:235], v[184:187], 0
    s_mul_i32 s59, s44, 14
    s_add_u32 m0, s101, 73728
    s_nop 0
    buffer_load_dwordx4 v2, s[16:19], s59 offen lds
    s_waitcnt lgkmcnt(10)
    v_mfma_f32_16x16x32_bf16 v[140:143], v[236:239], v[168:171], v[140:143]
    ds_read_b64 v[232:233], v9 offset:35008
    ds_read_b64 v[234:235], v10 offset:35008
    s_waitcnt lgkmcnt(7)
    v_mfma_f32_16x16x32_bf16 v[128:131], v[240:243], v[180:183], v[128:131]
    ds_read_b64 v[236:237], v9 offset:34496
    ds_read_b64 v[238:239], v10 offset:34496
    ds_read_b128 v[220:223], v11 offset:1088
    v_mfma_f32_16x16x32_bf16 v[132:135], v[240:243], v[184:187], v[132:135]
    v_mfma_f32_16x16x32_bf16 v[136:139], v[240:243], v[188:191], v[136:139]
    v_mfma_f32_16x16x32_bf16 v[140:143], v[240:243], v[192:195], v[140:143]
    ds_read_b128 v[224:227], v11 offset:576
    s_waitcnt lgkmcnt(9)
    v_mfma_f32_16x16x32_bf16 v[136:139], v[244:247], v[168:171], v[136:139]
    ds_read_b64 v[240:241], v9 offset:34752
    ds_read_b64 v[242:243], v10 offset:34752
    v_mfma_f32_16x16x32_bf16 v[140:143], v[244:247], v[172:175], v[140:143]
    s_mul_i32 s59, s0, 14
    s_add_u32 m0, s101, 16384
    s_nop 0
    buffer_load_dwordx4 v2, s[16:19], s59 offen lds
    s_waitcnt lgkmcnt(9)
    v_mfma_f32_16x16x32_bf16 v[128:131], v[248:251], v[176:179], v[128:131]
    ds_read_b64 v[244:245], v9 offset:33760
    ds_read_b64 v[246:247], v10 offset:33760
    ds_read_b128 v[228:231], v11 offset:64
    v_mfma_f32_16x16x32_bf16 v[132:135], v[248:251], v[180:183], v[132:135]
    v_mfma_f32_16x16x32_bf16 v[136:139], v[248:251], v[184:187], v[136:139]
    v_mfma_f32_16x16x32_bf16 v[140:143], v[248:251], v[188:191], v[140:143]
    ds_read_b128 v[200:203], v11 offset:3648
    s_waitcnt lgkmcnt(10)
    v_mfma_f32_16x16x32_bf16 v[132:135], v[232:235], v[168:171], v[132:135]
    ds_read_b64 v[248:249], v9 offset:35552
    ds_read_b64 v[250:251], v10 offset:35552
    v_mfma_f32_16x16x32_bf16 v[136:139], v[232:235], v[172:175], v[136:139]
    v_mfma_f32_16x16x32_bf16 v[140:143], v[232:235], v[176:179], v[140:143]
    s_mul_i32 s59, s1, 14
    s_add_u32 m0, s101, 0
    s_nop 0
    buffer_load_dwordx4 v2, s[16:19], s59 offen lds
    ds_read_b128 v[212:215], v11 offset:2112
    s_waitcnt lgkmcnt(11)
    v_mfma_f32_16x16x32_bf16 v[128:131], v[236:239], v[172:175], v[128:131]
    ds_read_b64 v[232:233], v9 offset:34016
    ds_read_b64 v[234:235], v10 offset:34016
    v_mfma_f32_16x16x32_bf16 v[132:135], v[236:239], v[176:179], v[132:135]
    v_mfma_f32_16x16x32_bf16 v[136:139], v[236:239], v[180:183], v[136:139]
    ds_read_b128 v[208:211], v11 offset:2624
    v_mfma_f32_16x16x32_bf16 v[140:143], v[236:239], v[184:187], v[140:143]
    s_waitcnt lgkmcnt(10)
    v_mfma_f32_16x16x32_bf16 v[128:131], v[240:243], v[168:171], v[128:131]
    ds_read_b64 v[236:237], v9 offset:35296
    ds_read_b64 v[238:239], v10 offset:35296
    v_mfma_f32_16x16x32_bf16 v[132:135], v[240:243], v[172:175], v[132:135]
    ds_read_b128 v[204:207], v11 offset:3136
    v_mfma_f32_16x16x32_bf16 v[136:139], v[240:243], v[176:179], v[136:139]
    v_mfma_f32_16x16x32_bf16 v[140:143], v[240:243], v[180:183], v[140:143]
    s_waitcnt lgkmcnt(11)
    v_mfma_f32_16x16x32_bf16 v[128:131], v[244:247], v[216:219], v[128:131]
    ds_read_b64 v[240:241], v9 offset:34272
    ds_read_b64 v[242:243], v10 offset:34272
    v_mfma_f32_16x16x32_bf16 v[132:135], v[244:247], v[220:223], v[132:135]
    v_mfma_f32_16x16x32_bf16 v[136:139], v[244:247], v[224:227], v[136:139]
    ds_read_b128 v[184:187], v11 offset:1664
    s_waitcnt lgkmcnt(13)
    v_mfma_f32_16x16x32_bf16 v[140:143], v[244:247], v[228:231], v[140:143]
    s_waitcnt lgkmcnt(10)
    v_mfma_f32_16x16x32_bf16 v[140:143], v[248:251], v[200:203], v[140:143]
    ds_read_b64 v[244:245], v9 offset:35040
    ds_read_b64 v[246:247], v10 offset:35040
    s_waitcnt lgkmcnt(9)
    v_mfma_f32_16x16x32_bf16 v[128:131], v[232:235], v[212:215], v[128:131]
    ds_read_b64 v[248:249], v9 offset:34528
    ds_read_b64 v[250:251], v10 offset:34528
    ds_read_b128 v[188:191], v11 offset:1152
    v_mfma_f32_16x16x32_bf16 v[132:135], v[232:235], v[216:219], v[132:135]
    v_mfma_f32_16x16x32_bf16 v[136:139], v[232:235], v[220:223], v[136:139]
    v_mfma_f32_16x16x32_bf16 v[140:143], v[232:235], v[224:227], v[140:143]
    ds_read_b128 v[192:195], v11 offset:640
    s_waitcnt lgkmcnt(10)
    v_mfma_f32_16x16x32_bf16 v[136:139], v[236:239], v[200:203], v[136:139]
    ds_read_b64 v[232:233], v9 offset:34784
    ds_read_b64 v[234:235], v10 offset:34784
    s_waitcnt lgkmcnt(11)
    v_mfma_f32_16x16x32_bf16 v[140:143], v[236:239], v[204:207], v[140:143]
    s_waitcnt lgkmcnt(9)
    v_mfma_f32_16x16x32_bf16 v[128:131], v[240:243], v[208:211], v[128:131]
    ds_read_b64 v[236:237], v9 offset:33792
    ds_read_b64 v[238:239], v10 offset:33792
    ds_read_b128 v[196:199], v11 offset:128
    v_mfma_f32_16x16x32_bf16 v[132:135], v[240:243], v[212:215], v[132:135]
    v_mfma_f32_16x16x32_bf16 v[136:139], v[240:243], v[216:219], v[136:139]
    v_mfma_f32_16x16x32_bf16 v[140:143], v[240:243], v[220:223], v[140:143]
    ds_read_b128 v[168:171], v11 offset:3712
    s_waitcnt lgkmcnt(10)
    v_mfma_f32_16x16x32_bf16 v[132:135], v[244:247], v[200:203], v[132:135]
    ds_read_b64 v[240:241], v9 offset:35584
    ds_read_b64 v[242:243], v10 offset:35584
    v_mfma_f32_16x16x32_bf16 v[136:139], v[244:247], v[204:207], v[136:139]
    v_mfma_f32_16x16x32_bf16 v[140:143], v[244:247], v[208:211], v[140:143]
    ds_read_b128 v[180:183], v11 offset:2176
    s_waitcnt lgkmcnt(11)
    v_mfma_f32_16x16x32_bf16 v[128:131], v[248:251], v[204:207], v[128:131]
    ds_read_b64 v[244:245], v9 offset:34048
    ds_read_b64 v[246:247], v10 offset:34048
    v_mfma_f32_16x16x32_bf16 v[132:135], v[248:251], v[208:211], v[132:135]
    v_mfma_f32_16x16x32_bf16 v[136:139], v[248:251], v[212:215], v[136:139]
    ds_read_b128 v[176:179], v11 offset:2688
    v_mfma_f32_16x16x32_bf16 v[140:143], v[248:251], v[216:219], v[140:143]
    s_waitcnt lgkmcnt(10)
    v_mfma_f32_16x16x32_bf16 v[128:131], v[232:235], v[200:203], v[128:131]
    ds_read_b64 v[248:249], v9 offset:35328
    ds_read_b64 v[250:251], v10 offset:35328
    v_mfma_f32_16x16x32_bf16 v[132:135], v[232:235], v[204:207], v[132:135]
    ds_read_b128 v[172:175], v11 offset:3200
    v_mfma_f32_16x16x32_bf16 v[136:139], v[232:235], v[208:211], v[136:139]
    v_mfma_f32_16x16x32_bf16 v[140:143], v[232:235], v[212:215], v[140:143]
    s_waitcnt lgkmcnt(11)
    v_mfma_f32_16x16x32_bf16 v[128:131], v[236:239], v[184:187], v[128:131]
    ds_read_b64 v[232:233], v9 offset:34304
    ds_read_b64 v[234:235], v10 offset:34304
    v_mfma_f32_16x16x32_bf16 v[132:135], v[236:239], v[188:191], v[132:135]
    v_mfma_f32_16x16x32_bf16 v[136:139], v[236:239], v[192:195], v[136:139]
    ds_read_b128 v[216:219], v11 offset:1728
    s_waitcnt lgkmcnt(13)
    v_mfma_f32_16x16x32_bf16 v[140:143], v[236:239], v[196:199], v[140:143]
    s_waitcnt lgkmcnt(10)
    v_mfma_f32_16x16x32_bf16 v[140:143], v[240:243], v[168:171], v[140:143]
    ds_read_b64 v[236:237], v9 offset:35072
    ds_read_b64 v[238:239], v10 offset:35072
    s_waitcnt lgkmcnt(9)
    v_mfma_f32_16x16x32_bf16 v[128:131], v[244:247], v[180:183], v[128:131]
    ds_read_b64 v[240:241], v9 offset:34560
    ds_read_b64 v[242:243], v10 offset:34560
    ds_read_b128 v[220:223], v11 offset:1216
    v_mfma_f32_16x16x32_bf16 v[132:135], v[244:247], v[184:187], v[132:135]
    v_mfma_f32_16x16x32_bf16 v[136:139], v[244:247], v[188:191], v[136:139]
    v_mfma_f32_16x16x32_bf16 v[140:143], v[244:247], v[192:195], v[140:143]
    ds_read_b128 v[224:227], v11 offset:704
    s_waitcnt lgkmcnt(10)
    v_mfma_f32_16x16x32_bf16 v[136:139], v[248:251], v[168:171], v[136:139]
    ds_read_b64 v[244:245], v9 offset:34816
    ds_read_b64 v[246:247], v10 offset:34816
    s_waitcnt lgkmcnt(11)
    v_mfma_f32_16x16x32_bf16 v[140:143], v[248:251], v[172:175], v[140:143]
    s_waitcnt lgkmcnt(9)
    v_mfma_f32_16x16x32_bf16 v[128:131], v[232:235], v[176:179], v[128:131]
    ds_read_b64 v[248:249], v9 offset:33824
    ds_read_b64 v[250:251], v10 offset:33824
    ds_read_b128 v[228:231], v11 offset:192
    v_mfma_f32_16x16x32_bf16 v[132:135], v[232:235], v[180:183], v[132:135]
    v_mfma_f32_16x16x32_bf16 v[136:139], v[232:235], v[184:187], v[136:139]
    v_mfma_f32_16x16x32_bf16 v[140:143], v[232:235], v[188:191], v[140:143]
    ds_read_b128 v[200:203], v11 offset:3776
    s_waitcnt lgkmcnt(10)
    v_mfma_f32_16x16x32_bf16 v[132:135], v[236:239], v[168:171], v[132:135]
    ds_read_b64 v[232:233], v9 offset:35616
    ds_read_b64 v[234:235], v10 offset:35616
    v_mfma_f32_16x16x32_bf16 v[136:139], v[236:239], v[172:175], v[136:139]
    v_mfma_f32_16x16x32_bf16 v[140:143], v[236:239], v[176:179], v[140:143]
    ds_read_b128 v[212:215], v11 offset:2240
    s_waitcnt lgkmcnt(11)
    v_mfma_f32_16x16x32_bf16 v[128:131], v[240:243], v[172:175], v[128:131]
    ds_read_b64 v[236:237], v9 offset:34080
    ds_read_b64 v[238:239], v10 offset:34080
    v_mfma_f32_16x16x32_bf16 v[132:135], v[240:243], v[176:179], v[132:135]
    v_mfma_f32_16x16x32_bf16 v[136:139], v[240:243], v[180:183], v[136:139]
    ds_read_b128 v[208:211], v11 offset:2752
    v_mfma_f32_16x16x32_bf16 v[140:143], v[240:243], v[184:187], v[140:143]
    s_waitcnt lgkmcnt(10)
    v_mfma_f32_16x16x32_bf16 v[128:131], v[244:247], v[168:171], v[128:131]
    ds_read_b64 v[240:241], v9 offset:35360
    ds_read_b64 v[242:243], v10 offset:35360
    v_mfma_f32_16x16x32_bf16 v[132:135], v[244:247], v[172:175], v[132:135]
    ds_read_b128 v[204:207], v11 offset:3264
    v_mfma_f32_16x16x32_bf16 v[136:139], v[244:247], v[176:179], v[136:139]
    v_mfma_f32_16x16x32_bf16 v[140:143], v[244:247], v[180:183], v[140:143]
    s_waitcnt lgkmcnt(11)
    v_mfma_f32_16x16x32_bf16 v[128:131], v[248:251], v[216:219], v[128:131]
    v_add_u32 v2, 4096, v12
    ds_read_b64 v[244:245], v9 offset:34336
    ds_read_b64 v[246:247], v10 offset:34336
    v_mfma_f32_16x16x32_bf16 v[132:135], v[248:251], v[220:223], v[132:135]
    v_mfma_f32_16x16x32_bf16 v[136:139], v[248:251], v[224:227], v[136:139]
    buffer_load_dwordx4 v[160:163], v12, s[20:23], s48 offen sc1
    s_waitcnt lgkmcnt(12)
    v_mfma_f32_16x16x32_bf16 v[140:143], v[248:251], v[228:231], v[140:143]
    s_waitcnt lgkmcnt(9)
    v_mfma_f32_16x16x32_bf16 v[140:143], v[232:235], v[200:203], v[140:143]
    buffer_load_dwordx4 v[164:167], v12, s[20:23], s49 offen sc1
    ds_read_b64 v[248:249], v9 offset:35104
    ds_read_b64 v[250:251], v10 offset:35104
    s_waitcnt lgkmcnt(8)
    v_mfma_f32_16x16x32_bf16 v[128:131], v[236:239], v[212:215], v[128:131]
    ds_read_b64 v[232:233], v9 offset:34592
    ds_read_b64 v[234:235], v10 offset:34592
    v_mfma_f32_16x16x32_bf16 v[132:135], v[236:239], v[216:219], v[132:135]
    buffer_load_dwordx4 v[168:171], v12, s[20:23], s50 offen sc1
    v_mfma_f32_16x16x32_bf16 v[136:139], v[236:239], v[220:223], v[136:139]
    v_mfma_f32_16x16x32_bf16 v[140:143], v[236:239], v[224:227], v[140:143]
    buffer_load_dwordx4 v[172:175], v12, s[20:23], s51 offen sc1
    s_waitcnt lgkmcnt(7)
    v_mfma_f32_16x16x32_bf16 v[136:139], v[240:243], v[200:203], v[136:139]
    ds_read_b64 v[236:237], v9 offset:34848
    ds_read_b64 v[238:239], v10 offset:34848
    s_waitcnt lgkmcnt(8)
    v_mfma_f32_16x16x32_bf16 v[140:143], v[240:243], v[204:207], v[140:143]
    buffer_load_dwordx4 v[176:179], v12, s[20:23], s52 offen sc1
    s_waitcnt lgkmcnt(6)
    v_mfma_f32_16x16x32_bf16 v[128:131], v[244:247], v[208:211], v[128:131]
    v_mfma_f32_16x16x32_bf16 v[132:135], v[244:247], v[212:215], v[132:135]
    buffer_load_dwordx4 v[180:183], v12, s[20:23], s53 offen sc1
    v_mfma_f32_16x16x32_bf16 v[136:139], v[244:247], v[216:219], v[136:139]
    v_mfma_f32_16x16x32_bf16 v[140:143], v[244:247], v[220:223], v[140:143]
    buffer_load_dwordx4 v[184:187], v12, s[20:23], s96 offen sc1
    s_waitcnt lgkmcnt(4)
    v_mfma_f32_16x16x32_bf16 v[132:135], v[248:251], v[200:203], v[132:135]
    v_mfma_f32_16x16x32_bf16 v[136:139], v[248:251], v[204:207], v[136:139]
    buffer_load_dwordx4 v[188:191], v12, s[20:23], s97 offen sc1
    v_mfma_f32_16x16x32_bf16 v[140:143], v[248:251], v[208:211], v[140:143]
    s_waitcnt lgkmcnt(2)
    v_mfma_f32_16x16x32_bf16 v[128:131], v[232:235], v[204:207], v[128:131]
    buffer_load_dwordx4 v[192:195], v12, s[20:23], s40 offen sc1
    v_mfma_f32_16x16x32_bf16 v[132:135], v[232:235], v[208:211], v[132:135]
    v_mfma_f32_16x16x32_bf16 v[136:139], v[232:235], v[212:215], v[136:139]
    buffer_load_dwordx4 v[196:199], v12, s[20:23], s41 offen sc1
    v_mfma_f32_16x16x32_bf16 v[140:143], v[232:235], v[216:219], v[140:143]
    s_waitcnt lgkmcnt(0)
    v_mfma_f32_16x16x32_bf16 v[128:131], v[236:239], v[200:203], v[128:131]
    v_mfma_f32_16x16x32_bf16 v[132:135], v[236:239], v[204:207], v[132:135]
    v_mfma_f32_16x16x32_bf16 v[136:139], v[236:239], v[208:211], v[136:139]
    v_mfma_f32_16x16x32_bf16 v[140:143], v[236:239], v[212:215], v[140:143]
    s_setprio 0
    v_lshrrev_b32 v10, 4, v1
    v_lshlrev_b32 v9, 4, v1
    v_lshl_add_u32 v9, v10, 6, v9
    s_mul_i32 s60, s58, 10240
    s_add_u32 s60, s60, 29696
    v_add_u32 v9, s60, v9
    s_waitcnt lgkmcnt(0)
    s_barrier
    ds_write_b128 v9, v[128:131] offset:0
    ds_write_b128 v9, v[132:135] offset:1280
    ds_write_b128 v9, v[136:139] offset:2560
    ds_write_b128 v9, v[140:143] offset:3840
    v_mov_b32 v232, 73472
    s_waitcnt vmcnt(10)
    s_waitcnt lgkmcnt(0)
    s_barrier
    s_waitcnt vmcnt(9)
    v_perm_b32 v235, v163, v160, s36
    v_and_b32 v235, 0x101, v235
    v_and_b32 v160, -2, v160
    v_cmp_ne_u32 vcc, s37, v235
    v_and_b32 v163, -2, v163
    s_nop 1
    s_cbranch_vccnz L_rtL0
L_bkL0:
    v_mfma_f32_32x32x16_bf16 v[128:143], v[160:163], v[16:19], 0
    s_waitcnt vmcnt(8)
    v_perm_b32 v235, v167, v164, s36
    v_and_b32 v235, 0x101, v235
    v_and_b32 v164, -2, v164
    v_cmp_ne_u32 vcc, s37, v235
    v_and_b32 v167, -2, v167
    v_mfma_f32_32x32x16_bf16 v[144:159], v[160:163], v[20:23], 0
    buffer_load_dwordx4 v[160:163], v12, s[20:23], s43 offen sc1
    s_cbranch_vccnz L_rtL1
L_bkL1:
    v_mfma_f32_32x32x16_bf16 v[128:143], v[164:167], v[24:27], v[128:143]
    s_waitcnt vmcnt(8)
    v_perm_b32 v235, v171, v168, s36
    v_and_b32 v235, 0x101, v235
    v_and_b32 v168, -2, v168
    v_cmp_ne_u32 vcc, s37, v235
    v_and_b32 v171, -2, v171
    v_mfma_f32_32x32x16_bf16 v[144:159], v[164:167], v[28:31], v[144:159]
    buffer_load_dwordx4 v[164:167], v12, s[20:23], s44 offen sc1
    s_cbranch_vccnz L_rtL2
L_bkL2:
    v_mfma_f32_32x32x16_bf16 v[128:143], v[168:171], v[32:35], v[128:143]
    s_waitcnt vmcnt(8)
    v_perm_b32 v235, v175, v172, s36
    v_and_b32 v235, 0x101, v235
    v_and_b32 v172, -2, v172
    v_cmp_ne_u32 vcc, s37, v235
    v_and_b32 v175, -2, v175
    v_mfma_f32_32x32x16_bf16 v[144:159], v[168:171], v[36:39], v[144:159]
    buffer_load_dwordx4 v[168:171], v12, s[20:23], s0 offen sc1
    s_cbranch_vccnz L_rtL3
L_bkL3:
    v_mfma_f32_32x32x16_bf16 v[128:143], v[172:175], v[40:43], v[128:143]
    s_waitcnt vmcnt(8)
    v_perm_b32 v235, v179, v176, s36
    v_and_b32 v235, 0x101, v235
    v_and_b32 v176, -2, v176
    v_cmp_ne_u32 vcc, s37, v235
    v_and_b32 v179, -2, v179
    v_mfma_f32_32x32x16_bf16 v[144:159], v[172:175], v[44:47], v[144:159]
    buffer_load_dwordx4 v[172:175], v12, s[20:23], s1 offen sc1
    s_cbranch_vccnz L_rtL4
L_bkL4:
    v_mfma_f32_32x32x16_bf16 v[128:143], v[176:179], v[48:51], v[128:143]
    s_waitcnt vmcnt(8)
    v_perm_b32 v235, v183, v180, s36
    v_and_b32 v235, 0x101, v235
    v_and_b32 v180, -2, v180
    v_cmp_ne_u32 vcc, s37, v235
    v_and_b32 v183, -2, v183
    v_mfma_f32_32x32x16_bf16 v[144:159], v[176:179], v[52:55], v[144:159]
    buffer_load_dwordx4 v[176:179], v2, s[20:23], s48 offen sc1
    s_cbranch_vccnz L_rtL5
L_bkL5:
    v_mfma_f32_32x32x16_bf16 v[128:143], v[180:183], v[56:59], v[128:143]
    v_bfe_u32 v10, v1, 1, 4
    v_and_b32 v14, 1, v1
    v_lshl_add_u32 v10, v14, 4, v10
    s_and_b32 s60, s3, 1
    s_waitcnt vmcnt(8)
    v_perm_b32 v235, v187, v184, s36
    v_and_b32 v235, 0x101, v235
    v_and_b32 v184, -2, v184
    v_cmp_ne_u32 vcc, s37, v235
    v_and_b32 v187, -2, v187
    v_mfma_f32_32x32x16_bf16 v[144:159], v[180:183], v[60:63], v[144:159]
    s_lshl_b32 s60, s60, 3
    s_andn2_b32 s61, s3, 1
    s_add_u32 s60, s60, s61
    v_lshrrev_b32 v13, 5, v1
    buffer_load_dwordx4 v[180:183], v2, s[20:23], s49 offen sc1
    s_cbranch_vccnz L_rtL6
L_bkL6:
    v_mfma_f32_32x32x16_bf16 v[128:143], v[184:187], v[64:67], v[128:143]
    v_add_u32 v13, s60, v13
    v_mul_u32_u24 v10, 272, v10
    v_lshl_add_u32 v10, v13, 4, v10
    s_and_b32 s60, s3, 3
    s_waitcnt vmcnt(8)
    v_perm_b32 v235, v191, v188, s36
    v_and_b32 v235, 0x101, v235
    v_and_b32 v188, -2, v188
    v_cmp_ne_u32 vcc, s37, v235
    v_and_b32 v191, -2, v191
    v_mfma_f32_32x32x16_bf16 v[144:159], v[184:187], v[68:71], v[144:159]
    s_lshl_b32 s60, s60, 13
    s_add_u32 s61, s60, 81920
    v_lshl_add_u32 v13, v1, 4, s61
    s_lshr_b32 s62, s3, 1
    buffer_load_dwordx4 v[184:187], v2, s[20:23], s50 offen sc1
    s_cbranch_vccnz L_rtL7
L_bkL7:
    v_mfma_f32_32x32x16_bf16 v[128:143], v[188:191], v[72:75], v[128:143]
    s_lshl_b32 s62, s62, 11
    s_xor_b32 s61, s60, 0x4000
    s_add_u32 s61, s61, s62
    s_add_u32 s61, s61, 81920
    s_waitcnt vmcnt(8)
    v_perm_b32 v235, v195, v192, s36
    v_and_b32 v235, 0x101, v235
    v_and_b32 v192, -2, v192
    v_cmp_ne_u32 vcc, s37, v235
    v_and_b32 v195, -2, v195
    v_mfma_f32_32x32x16_bf16 v[144:159], v[188:191], v[76:79], v[144:159]
    v_lshl_add_u32 v14, v1, 4, s61
    s_and_b32 s61, s60, 0x2000
    s_add_u32 s61, s61, s62
    s_add_u32 s61, s61, 24576
    buffer_load_dwordx4 v[188:191], v2, s[20:23], s51 offen sc1
    s_cbranch_vccnz L_rtL8
L_bkL8:
    v_mfma_f32_32x32x16_bf16 v[128:143], v[192:195], v[80:83], v[128:143]
    v_lshl_add_u32 v15, v1, 4, s61
    s_waitcnt vmcnt(8)
    v_perm_b32 v235, v199, v196, s36
    v_and_b32 v235, 0x101, v235
    v_and_b32 v196, -2, v196
    v_cmp_ne_u32 vcc, s37, v235
    v_and_b32 v199, -2, v199
    v_mfma_f32_32x32x16_bf16 v[144:159], v[192:195], v[84:87], v[144:159]
    buffer_load_dwordx4 v[192:195], v2, s[20:23], s52 offen sc1
    s_cbranch_vccnz L_rtL9
L_bkL9:
    v_mfma_f32_32x32x16_bf16 v[128:143], v[196:199], v[88:91], v[128:143]
    s_waitcnt vmcnt(8)
    v_perm_b32 v235, v163, v160, s36
    v_and_b32 v235, 0x101, v235
    v_and_b32 v160, -2, v160
    v_cmp_ne_u32 vcc, s37, v235
    v_and_b32 v163, -2, v163
    v_mfma_f32_32x32x16_bf16 v[144:159], v[196:199], v[92:95], v[144:159]
    buffer_load_dwordx4 v[196:199], v2, s[20:23], s53 offen sc1
    s_cbranch_vccnz L_rtL10
L_bkL10:
    v_mfma_f32_32x32x16_bf16 v[128:143], v[160:163], v[96:99], v[128:143]
    s_waitcnt vmcnt(8)
    v_perm_b32 v235, v167, v164, s36
    v_and_b32 v235, 0x101, v235
    v_and_b32 v164, -2, v164
    v_cmp_ne_u32 vcc, s37, v235
    v_and_b32 v167, -2, v167
    v_mfma_f32_32x32x16_bf16 v[144:159], v[160:163], v[100:103], v[144:159]
    buffer_load_dwordx4 v[160:163], v2, s[20:23], s96 offen sc1
    s_cbranch_vccnz L_rtL11
L_bkL11:
    v_mfma_f32_32x32x16_bf16 v[128:143], v[164:167], v[104:107], v[128:143]
    ds_read_b64_tr_b16 v[200:201], v5 offset:8192
    ds_read_b64_tr_b16 v[202:203], v5 offset:9216
    ds_read_b64_tr_b16 v[204:205], v6 offset:8192
    ds_read_b64_tr_b16 v[206:207], v6 offset:9216
    s_waitcnt vmcnt(8)
    v_perm_b32 v235, v171, v168, s36
    v_and_b32 v235, 0x101, v235
    v_and_b32 v168, -2, v168
    v_cmp_ne_u32 vcc, s37, v235
    v_and_b32 v171, -2, v171
    v_mfma_f32_32x32x16_bf16 v[144:159], v[164:167], v[108:111], v[144:159]
    buffer_load_dwordx4 v[164:167], v2, s[20:23], s97 offen sc1
    s_cbranch_vccnz L_rtL12
L_bkL12:
    v_mfma_f32_32x32x16_bf16 v[128:143], v[168:171], v[112:115], v[128:143]
    ds_read_b64_tr_b16 v[208:209], v3 offset:8192
    ds_read_b64_tr_b16 v[210:211], v3 offset:9216
    ds_read_b64_tr_b16 v[212:213], v4 offset:8192
    ds_read_b64_tr_b16 v[214:215], v4 offset:9216
    s_waitcnt vmcnt(8)
    v_perm_b32 v235, v175, v172, s36
    v_and_b32 v235, 0x101, v235
    v_and_b32 v172, -2, v172
    v_cmp_ne_u32 vcc, s37, v235
    v_and_b32 v175, -2, v175
    v_mfma_f32_32x32x16_bf16 v[144:159], v[168:171], v[116:119], v[144:159]
    buffer_load_dwordx4 v[168:171], v2, s[20:23], s40 offen sc1
    s_cbranch_vccnz L_rtL13
L_bkL13:
    v_mfma_f32_32x32x16_bf16 v[128:143], v[172:175], v[120:123], v[128:143]
    ds_read_b64_tr_b16 v[216:217], v3 offset:16384
    ds_read_b64_tr_b16 v[218:219], v3 offset:17408
    ds_read_b64_tr_b16 v[220:221], v4 offset:16384
    ds_read_b64_tr_b16 v[222:223], v4 offset:17408
    s_waitcnt vmcnt(8)
    v_perm_b32 v235, v179, v176, s36
    v_and_b32 v235, 0x101, v235
    v_and_b32 v176, -2, v176
    v_cmp_ne_u32 vcc, s37, v235
    v_and_b32 v179, -2, v179
    v_mfma_f32_32x32x16_bf16 v[144:159], v[172:175], v[124:127], v[144:159]
    buffer_load_dwordx4 v[172:175], v2, s[20:23], s41 offen sc1
    s_cbranch_vccnz L_rtL14
L_bkL14:
    s_waitcnt lgkmcnt(10)
    v_mfma_f32_32x32x16_bf16 v[128:143], v[176:179], v[200:203], v[128:143]
    ds_read_b64_tr_b16 v[224:225], v7 offset:8192
    ds_read_b64_tr_b16 v[226:227], v7 offset:9216
    ds_read_b64_tr_b16 v[228:229], v8 offset:8192
    ds_read_b64_tr_b16 v[230:231], v8 offset:9216
    s_waitcnt vmcnt(8)
    v_perm_b32 v235, v183, v180, s36
    v_and_b32 v235, 0x101, v235
    v_and_b32 v180, -2, v180
    v_cmp_ne_u32 vcc, s37, v235
    v_and_b32 v183, -2, v183
    s_waitcnt lgkmcnt(12)
    v_mfma_f32_32x32x16_bf16 v[144:159], v[176:179], v[204:207], v[144:159]
    buffer_load_dwordx4 v[176:179], v2, s[20:23], s43 offen sc1
    s_cbranch_vccnz L_rtL15
L_bkL15:
    s_waitcnt lgkmcnt(10)
    v_mfma_f32_32x32x16_bf16 v[128:143], v[180:183], v[208:211], v[128:143]
    ds_read_b64_tr_b16 v[200:201], v7 offset:16384
    ds_read_b64_tr_b16 v[202:203], v7 offset:17408
    ds_read_b64_tr_b16 v[204:205], v8 offset:16384
    ds_read_b64_tr_b16 v[206:207], v8 offset:17408
    s_waitcnt vmcnt(8)
    v_perm_b32 v235, v187, v184, s36
    v_and_b32 v235, 0x101, v235
    v_and_b32 v184, -2, v184
    v_cmp_ne_u32 vcc, s37, v235
    v_and_b32 v187, -2, v187
    s_waitcnt lgkmcnt(12)
    v_mfma_f32_32x32x16_bf16 v[144:159], v[180:183], v[212:215], v[144:159]
    buffer_load_dwordx4 v[180:183], v2, s[20:23], s44 offen sc1
    s_cbranch_vccnz L_rtL16
L_bkL16:
    s_waitcnt lgkmcnt(10)
    v_mfma_f32_32x32x16_bf16 v[128:143], v[184:187], v[216:219], v[128:143]
    ds_read_b64_tr_b16 v[208:209], v7 offset:24576
    ds_read_b64_tr_b16 v[210:211], v7 offset:25600
    ds_read_b64_tr_b16 v[212:213], v8 offset:24576
    ds_read_b64_tr_b16 v[214:215], v8 offset:25600
    s_waitcnt vmcnt(8)
    v_perm_b32 v235, v191, v188, s36
    v_and_b32 v235, 0x101, v235
    v_and_b32 v188, -2, v188
    v_cmp_ne_u32 vcc, s37, v235
    v_and_b32 v191, -2, v191
    s_waitcnt lgkmcnt(12)
    v_mfma_f32_32x32x16_bf16 v[144:159], v[184:187], v[220:223], v[144:159]
    buffer_load_dwordx4 v[184:187], v2, s[20:23], s0 offen sc1
    s_cbranch_vccnz L_rtL17
L_bkL17:
    s_waitcnt lgkmcnt(10)
    v_mfma_f32_32x32x16_bf16 v[128:143], v[188:191], v[224:227], v[128:143]
    ds_read_b64_tr_b16 v[216:217], v7 offset:32768
    ds_read_b64_tr_b16 v[218:219], v7 offset:33792
    ds_read_b64_tr_b16 v[220:221], v8 offset:32768
    ds_read_b64_tr_b16 v[222:223], v8 offset:33792
    s_waitcnt vmcnt(8)
    v_perm_b32 v235, v195, v192, s36
    v_and_b32 v235, 0x101, v235
    v_and_b32 v192, -2, v192
    v_cmp_ne_u32 vcc, s37, v235
    v_and_b32 v195, -2, v195
    s_waitcnt lgkmcnt(12)
    v_mfma_f32_32x32x16_bf16 v[144:159], v[188:191], v[228:231], v[144:159]
    buffer_load_dwordx4 v[188:191], v2, s[20:23], s1 offen sc1
    s_cbranch_vccnz L_rtL18
L_bkL18:
    s_waitcnt lgkmcnt(10)
    v_mfma_f32_32x32x16_bf16 v[128:143], v[192:195], v[200:203], v[128:143]
    ds_read_b64_tr_b16 v[224:225], v7 offset:40960
    ds_read_b64_tr_b16 v[226:227], v7 offset:41984
    ds_read_b64_tr_b16 v[228:229], v8 offset:40960
    ds_read_b64_tr_b16 v[230:231], v8 offset:41984
    v_bfe_u32 v246, v1, 1, 4
    v_and_b32 v247, 1, v1
    v_lshl_add_u32 v246, v247, 4, v246
    s_and_b32 s60, s3, 1
    s_lshl_b32 s60, s60, 3
    s_andn2_b32 s61, s3, 1
    s_add_u32 s60, s60, s61
    v_lshrrev_b32 v245, 5, v1
    v_add_u32 v245, s60, v245
    s_lshl_b32 s60, s98, 6
    v_lshl_add_u32 v245, v245, 2, s60
    v_mul_u32_u24 v245, 896, v245
    s_lshl_b32 s60, s99, 7
    v_lshl_add_u32 v246, v246, 2, s60
    v_add_u32 v245, v245, v246
    buffer_load_dword v252, v245, s[8:11], 0 offen offset:0
    buffer_load_dword v253, v245, s[8:11], 0 offen offset:896
    buffer_load_dword v254, v245, s[8:11], 0 offen offset:1792
    buffer_load_dword v255, v245, s[8:11], 0 offen offset:2688
    v_and_b32 v246, 31, v1
    v_lshl_add_u32 v246, v246, 1, s60
    s_mov_b32 s32, s54
    s_and_b32 s33, s55, 0xffff
    s_mov_b32 s34, 896
    s_mov_b32 s35, 0x00020000
    buffer_load_ushort v244, v246, s[32:35], 0 offen
    buffer_load_ushort v247, v246, s[32:35], 0 offen offset:64
    s_waitcnt vmcnt(14)
    v_perm_b32 v235, v199, v196, s36
    v_and_b32 v235, 0x101, v235
    v_and_b32 v196, -2, v196
    v_cmp_ne_u32 vcc, s37, v235
    v_and_b32 v199, -2, v199
    s_waitcnt lgkmcnt(12)
    v_mfma_f32_32x32x16_bf16 v[144:159], v[192:195], v[204:207], v[144:159]
    s_cbranch_vccnz L_rtL19
L_bkL19:
    s_waitcnt lgkmcnt(10)
    v_mfma_f32_32x32x16_bf16 v[128:143], v[196:199], v[208:211], v[128:143]
    ds_read_b64_tr_b16 v[200:201], v7 offset:49152
    ds_read_b64_tr_b16 v[202:203], v7 offset:50176
    ds_read_b64_tr_b16 v[204:205], v8 offset:49152
    ds_read_b64_tr_b16 v[206:207], v8 offset:50176
    s_mul_i32 s60, s98, 114688
    s_lshl_b32 s61, s99, 14
    s_add_u32 s60, s60, s61
    s_lshl_b32 s61, s58, 12
    s_add_u32 s60, s60, s61
    s_add_u32 s60, s60, 16777216
    v_lshlrev_b32 v12, 4, v1
    s_waitcnt vmcnt(13)
    v_perm_b32 v235, v163, v160, s36
    v_and_b32 v235, 0x101, v235
    v_and_b32 v160, -2, v160
    v_cmp_ne_u32 vcc, s37, v235
    v_and_b32 v163, -2, v163
    s_waitcnt lgkmcnt(12)
    v_mfma_f32_32x32x16_bf16 v[144:159], v[196:199], v[212:215], v[144:159]
    v_lshrrev_b32 v11, 5, v1
    v_mul_u32_u24 v11, 272, v11
    v_and_b32 v9, 31, v1
    v_lshl_add_u32 v11, v9, 3, v11
    s_mul_i32 s61, s58, 2176
    s_add_u32 s61, s61, 59520
    v_add_u32 v11, s61, v11
    s_cbranch_vccnz L_rtL20
L_bkL20:
    s_waitcnt lgkmcnt(10)
    v_mfma_f32_32x32x16_bf16 v[128:143], v[160:163], v[216:219], v[128:143]
    ds_read_b64_tr_b16 v[208:209], v7 offset:57344
    ds_read_b64_tr_b16 v[210:211], v7 offset:58368
    ds_read_b64_tr_b16 v[212:213], v8 offset:57344
    ds_read_b64_tr_b16 v[214:215], v8 offset:58368
    buffer_load_dwordx4 v[16:19], v12, s[20:23], s60 offen offset:0 sc1
    buffer_load_dwordx4 v[20:23], v12, s[20:23], s60 offen offset:1024 sc1
    buffer_load_dwordx4 v[24:27], v12, s[20:23], s60 offen offset:2048 sc1
    buffer_load_dwordx4 v[28:31], v12, s[20:23], s60 offen offset:3072 sc1
    s_waitcnt vmcnt(16)
    v_perm_b32 v235, v167, v164, s36
    v_and_b32 v235, 0x101, v235
    v_and_b32 v164, -2, v164
    v_cmp_ne_u32 vcc, s37, v235
    v_and_b32 v167, -2, v167
    s_waitcnt lgkmcnt(12)
    v_mfma_f32_32x32x16_bf16 v[144:159], v[160:163], v[220:223], v[144:159]
    s_cbranch_vccnz L_rtL21
L_bkL21:
    s_waitcnt lgkmcnt(10)
    v_mfma_f32_32x32x16_bf16 v[128:143], v[164:167], v[224:227], v[128:143]
    ds_read_b64_tr_b16 v[216:217], v3 offset:0
    ds_read_b64_tr_b16 v[218:219], v3 offset:1024
    ds_read_b64_tr_b16 v[220:221], v4 offset:0
    ds_read_b64_tr_b16 v[222:223], v4 offset:1024
    s_waitcnt vmcnt(15)
    v_perm_b32 v235, v171, v168, s36
    v_and_b32 v235, 0x101, v235
    v_and_b32 v168, -2, v168
    v_cmp_ne_u32 vcc, s37, v235
    v_and_b32 v171, -2, v171
    s_waitcnt lgkmcnt(12)
    v_mfma_f32_32x32x16_bf16 v[144:159], v[164:167], v[228:231], v[144:159]
    v_mov_b32 v232, 73472
    s_mov_b64 exec, 1
    v_mov_b32 v233, 1
    ds_add_u32 v232, v233 offset:240
    s_mov_b64 exec, -1
    s_cbranch_vccnz L_rtL22
L_bkL22:
    s_waitcnt lgkmcnt(11)
    v_mfma_f32_32x32x16_bf16 v[128:143], v[168:171], v[200:203], v[128:143]
    ds_read_b64_tr_b16 v[224:225], v7 offset:0
    ds_read_b64_tr_b16 v[226:227], v7 offset:1024
    ds_read_b64_tr_b16 v[228:229], v8 offset:0
    ds_read_b64_tr_b16 v[230:231], v8 offset:1024
    s_waitcnt vmcnt(14)
    v_perm_b32 v235, v175, v172, s36
    v_and_b32 v235, 0x101, v235
    v_and_b32 v172, -2, v172
    v_cmp_ne_u32 vcc, s37, v235
    v_and_b32 v175, -2, v175
    s_waitcnt lgkmcnt(13)
    v_mfma_f32_32x32x16_bf16 v[144:159], v[168:171], v[204:207], v[144:159]
    s_cbranch_vccnz L_rtL23
L_bkL23:
    s_waitcnt lgkmcnt(11)
    v_mfma_f32_32x32x16_bf16 v[128:143], v[172:175], v[208:211], v[128:143]
    ds_read_b64_tr_b16 v[200:201], v5 offset:16384
    ds_read_b64_tr_b16 v[202:203], v5 offset:17408
    ds_read_b64_tr_b16 v[204:205], v6 offset:16384
    ds_read_b64_tr_b16 v[206:207], v6 offset:17408
    s_waitcnt vmcnt(13)
    v_perm_b32 v235, v179, v176, s36
    v_and_b32 v235, 0x101, v235
    v_and_b32 v176, -2, v176
    v_cmp_ne_u32 vcc, s37, v235
    v_and_b32 v179, -2, v179
    s_waitcnt lgkmcnt(13)
    v_mfma_f32_32x32x16_bf16 v[144:159], v[172:175], v[212:215], v[144:159]
    s_cbranch_vccnz L_rtL24
L_bkL24:
    s_waitcnt lgkmcnt(11)
    v_mfma_f32_32x32x16_bf16 v[128:143], v[176:179], v[216:219], v[128:143]
    ds_read_b64_tr_b16 v[208:209], v5 offset:0
    ds_read_b64_tr_b16 v[210:211], v5 offset:1024
    ds_read_b64_tr_b16 v[212:213], v6 offset:0
    ds_read_b64_tr_b16 v[214:215], v6 offset:1024
    s_waitcnt vmcnt(12)
    v_perm_b32 v235, v183, v180, s36
    v_and_b32 v235, 0x101, v235
    v_and_b32 v180, -2, v180
    v_cmp_ne_u32 vcc, s37, v235
    v_and_b32 v183, -2, v183
    s_waitcnt lgkmcnt(13)
    v_mfma_f32_32x32x16_bf16 v[144:159], v[176:179], v[220:223], v[144:159]
    ds_read_b32 v233, v232 offset:244
    s_cbranch_vccnz L_rtL25
L_bkL25:
    s_waitcnt lgkmcnt(11)
    v_mfma_f32_32x32x16_bf16 v[128:143], v[180:183], v[224:227], v[128:143]
    s_waitcnt vmcnt(11)
    v_perm_b32 v235, v187, v184, s36
    v_and_b32 v235, 0x101, v235
    v_and_b32 v184, -2, v184
    v_cmp_ne_u32 vcc, s37, v235
    v_and_b32 v187, -2, v187
    s_waitcnt lgkmcnt(9)
    v_mfma_f32_32x32x16_bf16 v[144:159], v[180:183], v[228:231], v[144:159]
    s_cbranch_vccnz L_rtL26
L_bkL26:
    s_waitcnt lgkmcnt(7)
    v_mfma_f32_32x32x16_bf16 v[128:143], v[184:187], v[200:203], v[128:143]
    s_waitcnt lgkmcnt(0)
    v_readfirstlane_b32 s62, v233
    s_nop 0
    s_cmp_ge_u32 s62, 4
    s_cbranch_scc1 L_ldh2
    v_mov_b32 v232, 73472
    s_mov_b32 s63, 0
L_lsh2:
    ds_read_b32 v233, v232 offset:244
    s_waitcnt lgkmcnt(0)
    v_readfirstlane_b32 s62, v233
    s_nop 0
    s_cmp_ge_u32 s62, 4
    s_cbranch_scc1 L_ldh2
    s_add_u32 s63, s63, 1
    s_cmp_lt_u32 s63, 200000
    s_cbranch_scc1 L_lsh2
L_ldh2:
    s_mov_b32 s63, 0
L_sck:
    s_waitcnt vmcnt(0)
    v_xor_b32 v17, s39, v17
    v_xor_b32 v19, s39, v19
    v_xor_b32 v21, s39, v21
    v_xor_b32 v23, s39, v23
    v_xor_b32 v25, s39, v25
    v_xor_b32 v27, s39, v27
    v_xor_b32 v29, s39, v29
    v_xor_b32 v31, s39, v31
    v_or3_b32 v17, v17, v19, v21
    v_or3_b32 v23, v23, v25, v27
    v_or3_b32 v17, v17, v29, v31
    v_or_b32 v17, v17, v23
    v_cmp_ne_u32 vcc, 0, v17
    s_nop 1
    s_cbranch_vccz L_sok
    s_add_u32 s63, s63, 1
    s_cmp_ge_u32 s63, 20000
    s_cbranch_scc1 L_sok
    buffer_load_dwordx4 v[16:19], v12, s[20:23], s60 offen offset:0 sc1
    buffer_load_dwordx4 v[20:23], v12, s[20:23], s60 offen offset:1024 sc1
    buffer_load_dwordx4 v[24:27], v12, s[20:23], s60 offen offset:2048 sc1
    buffer_load_dwordx4 v[28:31], v12, s[20:23], s60 offen offset:3072 sc1
    s_branch L_sck
L_sok:
    s_waitcnt vmcnt(0)
    v_mov_b32 v17, v18
    ds_write_b64 v11, v[16:17] offset:0
    v_mov_b32 v21, v22
    ds_write_b64 v11, v[20:21] offset:544
    v_mov_b32 v25, v26
    ds_write_b64 v11, v[24:25] offset:1088
    v_mov_b32 v29, v30
    ds_write_b64 v11, v[28:29] offset:1632
    v_perm_b32 v235, v191, v188, s36
    v_and_b32 v235, 0x101, v235
    v_and_b32 v188, -2, v188
    v_cmp_ne_u32 vcc, s37, v235
    v_and_b32 v191, -2, v191
    v_mfma_f32_32x32x16_bf16 v[144:159], v[184:187], v[204:207], v[144:159]
    s_cbranch_vccnz L_rtL27
L_bkL27:
    v_mfma_f32_32x32x16_bf16 v[128:143], v[188:191], v[208:211], v[128:143]
    ds_read_b32 v233, v232 offset:240
    v_mfma_f32_32x32x16_bf16 v[144:159], v[188:191], v[212:215], v[144:159]
    s_waitcnt lgkmcnt(0)
    v_readfirstlane_b32 s62, v233
    s_nop 0
    s_cmp_ge_u32 s62, 1028
    s_cbranch_scc1 L_ldl2
    v_mov_b32 v232, 73472
    s_mov_b32 s63, 0
L_lsl2:
    ds_read_b32 v233, v232 offset:240
    s_waitcnt lgkmcnt(0)
    v_readfirstlane_b32 s62, v233
    s_nop 0
    s_cmp_ge_u32 s62, 1028
    s_cbranch_scc1 L_ldl2
    s_add_u32 s63, s63, 1
    s_cmp_lt_u32 s63, 200000
    s_cbranch_scc1 L_lsl2
L_ldl2:
    v_lshlrev_b32 v192, 16, v252
    v_and_b32 v196, 0xffff0000, v252
    v_lshlrev_b32 v193, 16, v253
    v_and_b32 v197, 0xffff0000, v253
    v_lshlrev_b32 v194, 16, v254
    v_and_b32 v198, 0xffff0000, v254
    v_lshlrev_b32 v195, 16, v255
    v_and_b32 v199, 0xffff0000, v255
    s_mov_b32 s62, 0xbfb8aa3b
    v_lshlrev_b32 v244, 16, v244
    v_lshlrev_b32 v247, 16, v247
    v_mul_f32 v244, s62, v244
    v_mul_f32 v247, s62, v247
    s_bitcmp1_b32 s3, 1
    s_cbranch_scc1 L_pw10
    ds_write_b128 v13, v[132:135] offset:2048
    ds_write_b128 v13, v[136:139] offset:4096
    ds_write_b128 v13, v[140:143] offset:6144
    ds_write_b128 v13, v[148:151] offset:3072
    ds_write_b128 v13, v[152:155] offset:5120
    ds_write_b128 v13, v[156:159] offset:7168
    v_fma_f32 v160, v128, s62, v244
    v_fma_f32 v161, v129, s62, v244
    v_fma_f32 v162, v130, s62, v244
    v_fma_f32 v163, v131, s62, v244
    v_fma_f32 v164, v144, s62, v247
    v_fma_f32 v165, v145, s62, v247
    v_fma_f32 v166, v146, s62, v247
    v_fma_f32 v167, v147, s62, v247
    s_branch L_pw20
L_pw10:
    ds_write_b128 v13, v[128:131] offset:0
    ds_write_b128 v13, v[136:139] offset:4096
    ds_write_b128 v13, v[140:143] offset:6144
    ds_write_b128 v13, v[144:147] offset:1024
    ds_write_b128 v13, v[152:155] offset:5120
    ds_write_b128 v13, v[156:159] offset:7168
    v_fma_f32 v160, v132, s62, v244
    v_fma_f32 v161, v133, s62, v244
    v_fma_f32 v162, v134, s62, v244
    v_fma_f32 v163, v135, s62, v244
    v_fma_f32 v164, v148, s62, v247
    v_fma_f32 v165, v149, s62, v247
    v_fma_f32 v166, v150, s62, v247
    v_fma_f32 v167, v151, s62, v247
L_pw20:
    s_mov_b32 vcc_lo, 0x55555555
    s_mov_b32 vcc_hi, 0x55555555
    s_waitcnt vmcnt(0)
    s_branch L_fin
L_pH:
    s_setprio 2
    ds_read_b64 v[232:233], v9 offset:33728
    ds_read_b64 v[234:235], v10 offset:33728
    ds_read_b128 v[160:163], v11 offset:3584
    ds_read_b128 v[164:167], v11 offset:3072
    ds_read_b128 v[168:171], v11 offset:2560
    ds_read_b128 v[172:175], v11 offset:2048
    ds_read_b64 v[236:237], v9 offset:34496
    ds_read_b64 v[238:239], v10 offset:34496
    ds_read_b64 v[240:241], v9 offset:33984
    ds_read_b64 v[242:243], v10 offset:33984
    ds_read_b64 v[244:245], v9 offset:34240
    ds_read_b64 v[246:247], v10 offset:34240
    s_waitcnt lgkmcnt(6)
    v_mfma_f32_16x16x32_bf16 v[140:143], v[232:235], v[172:175], 0
    ds_read_b64 v[248:249], v9 offset:33760
    ds_read_b64 v[250:251], v10 offset:33760
    v_mfma_f32_16x16x32_bf16 v[136:139], v[232:235], v[168:171], 0
    s_mul_i32 s59, s97, 14
    s_add_u32 m0, s101, 114688
    s_nop 0
    buffer_load_dwordx4 v2, s[16:19], s59 offen lds
    ds_read_b128 v[176:179], v11 offset:3648
    v_mfma_f32_16x16x32_bf16 v[132:135], v[232:235], v[164:167], 0
    v_mfma_f32_16x16x32_bf16 v[128:131], v[232:235], v[160:163], 0
    ds_read_b128 v[180:183], v11 offset:3136
    s_waitcnt lgkmcnt(8)
    v_mfma_f32_16x16x32_bf16 v[140:143], v[236:239], v[160:163], v[140:143]
    s_mul_i32 s59, s40, 14
    s_add_u32 m0, s101, 122880
    s_nop 0
    buffer_load_dwordx4 v2, s[16:19], s59 offen lds
    ds_read_b64 v[232:233], v9 offset:34528
    ds_read_b64 v[234:235], v10 offset:34528
    s_waitcnt lgkmcnt(8)
    v_mfma_f32_16x16x32_bf16 v[132:135], v[240:243], v[160:163], v[132:135]
    ds_read_b64 v[236:237], v9 offset:34016
    ds_read_b64 v[238:239], v10 offset:34016
    ds_read_b128 v[184:187], v11 offset:2624
    v_mfma_f32_16x16x32_bf16 v[136:139], v[240:243], v[164:167], v[136:139]
    v_mfma_f32_16x16x32_bf16 v[140:143], v[240:243], v[168:171], v[140:143]
    s_mul_i32 s59, s41, 14
    s_add_u32 m0, s101, 131072
    s_nop 0
    buffer_load_dwordx4 v2, s[16:19], s59 offen lds
    ds_read_b128 v[188:191], v11 offset:2112
    s_waitcnt lgkmcnt(10)
    v_mfma_f32_16x16x32_bf16 v[136:139], v[244:247], v[160:163], v[136:139]
    ds_read_b64 v[240:241], v9 offset:34272
    ds_read_b64 v[242:243], v10 offset:34272
    v_mfma_f32_16x16x32_bf16 v[140:143], v[244:247], v[164:167], v[140:143]
    s_waitcnt lgkmcnt(9)
    v_mfma_f32_16x16x32_bf16 v[128:131], v[248:251], v[176:179], v[128:131]
    s_mul_i32 s59, s43, 14
    s_add_u32 m0, s101, 139264
    s_nop 0
    buffer_load_dwordx4 v2, s[16:19], s59 offen lds
    ds_read_b64 v[244:245], v9 offset:33792
    ds_read_b64 v[246:247], v10 offset:33792
    s_waitcnt lgkmcnt(10)
    v_mfma_f32_16x16x32_bf16 v[132:135], v[248:251], v[180:183], v[132:135]
    ds_read_b128 v[160:163], v11 offset:3712
    s_waitcnt lgkmcnt(6)
    v_mfma_f32_16x16x32_bf16 v[136:139], v[248:251], v[184:187], v[136:139]
    v_add_f32 v196, v196, v197
    v_add_f32 v198, v198, v199
    v_add_f32 v196, v196, v198
    v_cvt_pk_bf16_f32 v208, v196, v196
    v_lshlrev_b32 v209, 16, v208
    v_sub_f32 v209, v196, v209
    v_cvt_pk_bf16_f32 v212, v196, v209
    v_and_b32 v208, 0xffff, v208
    v_lshl_or_b32 v213, v15, 16, v208
    s_nop 1
    v_mfma_f32_32x32x16_bf16 v[144:159], v[212:215], v[216:219], v[144:159]
    s_waitcnt lgkmcnt(5)
    v_mfma_f32_16x16x32_bf16 v[140:143], v[248:251], v[188:191], v[140:143]
    s_mul_i32 s59, s44, 14
    s_add_u32 m0, s101, 73728
    s_nop 0
    buffer_load_dwordx4 v2, s[16:19], s59 offen lds
    ds_read_b128 v[164:167], v11 offset:3200
    v_mfma_f32_16x16x32_bf16 v[140:143], v[232:235], v[176:179], v[140:143]
    ds_read_b64 v[248:249], v9 offset:34560
    ds_read_b64 v[250:251], v10 offset:34560
    v_mfma_f32_16x16x32_bf16 v[132:135], v[236:239], v[176:179], v[132:135]
    ds_read_b64 v[232:233], v9 offset:34048
    ds_read_b64 v[234:235], v10 offset:34048
    ds_read_b128 v[168:171], v11 offset:2688
    v_mfma_f32_16x16x32_bf16 v[136:139], v[236:239], v[180:183], v[136:139]
    s_mul_i32 s59, s0, 14
    s_add_u32 m0, s101, 16384
    s_nop 0
    buffer_load_dwordx4 v2, s[16:19], s59 offen lds
    v_mfma_f32_16x16x32_bf16 v[140:143], v[236:239], v[184:187], v[140:143]
    ds_read_b128 v[172:175], v11 offset:2176
    s_waitcnt lgkmcnt(10)
    v_mfma_f32_16x16x32_bf16 v[136:139], v[240:243], v[176:179], v[136:139]
    ds_read_b64 v[236:237], v9 offset:34304
    ds_read_b64 v[238:239], v10 offset:34304
    v_mfma_f32_16x16x32_bf16 v[140:143], v[240:243], v[180:183], v[140:143]
    s_mul_i32 s59, s1, 14
    s_add_u32 m0, s101, 0
    s_nop 0
    buffer_load_dwordx4 v2, s[16:19], s59 offen lds
    s_waitcnt lgkmcnt(9)
    v_mfma_f32_16x16x32_bf16 v[128:131], v[244:247], v[160:163], v[128:131]
    ds_read_b64 v[240:241], v9 offset:33824
    ds_read_b64 v[242:243], v10 offset:33824
    s_waitcnt lgkmcnt(10)
    v_mfma_f32_16x16x32_bf16 v[132:135], v[244:247], v[164:167], v[132:135]
    ds_read_b128 v[176:179], v11 offset:3776
    s_waitcnt lgkmcnt(6)
    v_mfma_f32_16x16x32_bf16 v[136:139], v[244:247], v[168:171], v[136:139]
    s_waitcnt lgkmcnt(5)
    v_mfma_f32_16x16x32_bf16 v[140:143], v[244:247], v[172:175], v[140:143]
    ds_read_b128 v[180:183], v11 offset:3264
    v_mfma_f32_16x16x32_bf16 v[140:143], v[248:251], v[160:163], v[140:143]
    ds_read_b64 v[244:245], v9 offset:34592
    ds_read_b64 v[246:247], v10 offset:34592
    v_mfma_f32_16x16x32_bf16 v[132:135], v[232:235], v[160:163], v[132:135]
    ds_read_b64 v[248:249], v9 offset:34080
    ds_read_b64 v[250:251], v10 offset:34080
    ds_read_b128 v[184:187], v11 offset:2752
    v_mfma_f32_16x16x32_bf16 v[136:139], v[232:235], v[164:167], v[136:139]
    v_mfma_f32_16x16x32_bf16 v[140:143], v[232:235], v[168:171], v[140:143]
    ds_read_b128 v[188:191], v11 offset:2240
    s_waitcnt lgkmcnt(10)
    v_mfma_f32_16x16x32_bf16 v[136:139], v[236:239], v[160:163], v[136:139]
    ds_read_b64 v[232:233], v9 offset:34336
    ds_read_b64 v[234:235], v10 offset:34336
    v_mfma_f32_16x16x32_bf16 v[140:143], v[236:239], v[164:167], v[140:143]
    s_waitcnt lgkmcnt(9)
    v_mfma_f32_16x16x32_bf16 v[128:131], v[240:243], v[176:179], v[128:131]
    s_waitcnt lgkmcnt(8)
    v_mfma_f32_16x16x32_bf16 v[132:135], v[240:243], v[180:183], v[132:135]
    s_waitcnt lgkmcnt(3)
    v_mfma_f32_16x16x32_bf16 v[136:139], v[240:243], v[184:187], v[136:139]
    s_waitcnt lgkmcnt(2)
    v_mfma_f32_16x16x32_bf16 v[140:143], v[240:243], v[188:191], v[140:143]
    v_mfma_f32_16x16x32_bf16 v[140:143], v[244:247], v[176:179], v[140:143]
    v_mfma_f32_16x16x32_bf16 v[132:135], v[248:251], v[176:179], v[132:135]
    v_mfma_f32_16x16x32_bf16 v[136:139], v[248:251], v[180:183], v[136:139]
    v_mfma_f32_16x16x32_bf16 v[140:143], v[248:251], v[184:187], v[140:143]
    s_waitcnt lgkmcnt(0)
    v_mfma_f32_16x16x32_bf16 v[136:139], v[232:235], v[176:179], v[136:139]
    v_mfma_f32_16x16x32_bf16 v[140:143], v[232:235], v[180:183], v[140:143]
    s_setprio 1
    v_mul_f32 v224, v144, v144
    v_mul_f32 v225, v145, v145
    v_fma_f32 v224, v224, v221, v220
    v_fma_f32 v225, v225, v221, v220
    v_mul_f32 v224, v144, v224
    v_mul_f32 v225, v145, v225
    buffer_load_dwordx4 v[160:163], v12, s[20:23], s48 offen sc1
    v_exp_f32 v224, v224
    v_mul_f32 v226, v146, v146
    v_mul_f32 v227, v147, v147
    v_exp_f32 v225, v225
    v_fma_f32 v226, v226, v221, v220
    v_fma_f32 v227, v227, v221, v220
    v_mul_f32 v226, v146, v226
    v_mul_f32 v227, v147, v227
    v_exp_f32 v226, v226
    v_fma_f32 v224, v224, v222, v222
    v_mul_f32 v228, v148, v148
    v_mul_f32 v229, v149, v149
    buffer_load_dwordx4 v[164:167], v12, s[20:23], s49 offen sc1
    v_exp_f32 v227, v227
    v_fma_f32 v225, v225, v222, v222
    v_fma_f32 v228, v228, v221, v220
    v_fma_f32 v229, v229, v221, v220
    v_rcp_f32 v224, v224
    v_mul_f32 v228, v148, v228
    v_rcp_f32 v225, v225
    v_mul_f32 v229, v149, v229
    v_mul_f32 v224, v144, v224
    v_mul_f32 v225, v145, v225
    v_exp_f32 v228, v228
    v_fma_f32 v226, v226, v222, v222
    buffer_load_dwordx4 v[168:171], v12, s[20:23], s50 offen sc1
    v_add_u32 v224, 0x10000, v224
    v_cvt_pk_bf16_f32 v248, v225, v225
    v_alignbit_b32 v248, v248, v224, 16
    v_bfi_b32 v248, 1, s45, v248
    v_mul_f32 v230, v150, v150
    v_mul_f32 v231, v151, v151
    v_exp_f32 v229, v229
    v_fma_f32 v227, v227, v222, v222
    v_fma_f32 v230, v230, v221, v220
    v_fma_f32 v231, v231, v221, v220
    v_rcp_f32 v226, v226
    v_mul_f32 v230, v150, v230
    buffer_load_dwordx4 v[172:175], v12, s[20:23], s51 offen sc1
    v_rcp_f32 v227, v227
    v_mul_f32 v231, v151, v231
    v_mul_f32 v226, v146, v226
    v_mul_f32 v227, v147, v227
    v_exp_f32 v230, v230
    v_fma_f32 v228, v228, v222, v222
    v_cvt_pk_bf16_f32 v249, v226, v227
    v_mul_f32 v224, v152, v152
    v_mul_f32 v225, v153, v153
    v_exp_f32 v231, v231
    v_fma_f32 v229, v229, v222, v222
    v_fma_f32 v224, v224, v221, v220
    buffer_load_dwordx4 v[176:179], v12, s[20:23], s52 offen sc1
    v_fma_f32 v225, v225, v221, v220
    v_rcp_f32 v228, v228
    v_mul_f32 v224, v152, v224
    v_rcp_f32 v229, v229
    v_mul_f32 v225, v153, v225
    v_mul_f32 v228, v148, v228
    v_mul_f32 v229, v149, v229
    v_exp_f32 v224, v224
    v_fma_f32 v230, v230, v222, v222
    v_cvt_pk_bf16_f32 v250, v228, v229
    v_mul_f32 v226, v154, v154
    v_mul_f32 v227, v155, v155
    buffer_load_dwordx4 v[180:183], v12, s[20:23], s53 offen sc1
    v_exp_f32 v225, v225
    v_fma_f32 v231, v231, v222, v222
    v_fma_f32 v226, v226, v221, v220
    v_fma_f32 v227, v227, v221, v220
    v_rcp_f32 v230, v230
    v_mul_f32 v226, v154, v226
    v_rcp_f32 v231, v231
    v_mul_f32 v227, v155, v227
    v_mul_f32 v230, v150, v230
    v_mul_f32 v231, v151, v231
    v_exp_f32 v226, v226
    v_fma_f32 v224, v224, v222, v222
    buffer_load_dwordx4 v[184:187], v12, s[20:23], s96 offen sc1
    v_add_u32 v230, 0x10000, v230
    v_cvt_pk_bf16_f32 v251, v231, v231
    v_alignbit_b32 v251, v251, v230, 16
    v_bfi_b32 v251, 1, s46, v251
    buffer_store_dwordx4 v[248:251], v13, s[20:23], 0 offen offset:0 sc1
    v_mul_f32 v228, v156, v156
    v_mul_f32 v229, v157, v157
    v_exp_f32 v227, v227
    v_fma_f32 v225, v225, v222, v222
    v_fma_f32 v228, v228, v221, v220
    v_fma_f32 v229, v229, v221, v220
    v_rcp_f32 v224, v224
    buffer_load_dwordx4 v[188:191], v12, s[20:23], s97 offen sc1
    v_mul_f32 v228, v156, v228
    v_rcp_f32 v225, v225
    v_mul_f32 v229, v157, v229
    v_mul_f32 v224, v152, v224
    v_mul_f32 v225, v153, v225
    v_exp_f32 v228, v228
    v_fma_f32 v226, v226, v222, v222
    v_add_u32 v224, 0x10000, v224
    v_cvt_pk_bf16_f32 v252, v225, v225
    v_alignbit_b32 v252, v252, v224, 16
    v_bfi_b32 v252, 1, s45, v252
    v_mul_f32 v230, v158, v158
    buffer_load_dwordx4 v[192:195], v12, s[20:23], s40 offen sc1
    v_mul_f32 v231, v159, v159
    v_exp_f32 v229, v229
    v_fma_f32 v227, v227, v222, v222
    v_fma_f32 v230, v230, v221, v220
    v_fma_f32 v231, v231, v221, v220
    v_rcp_f32 v226, v226
    v_mul_f32 v230, v158, v230
    v_rcp_f32 v227, v227
    v_mul_f32 v231, v159, v231
    v_mul_f32 v226, v154, v226
    v_mul_f32 v227, v155, v227
    v_exp_f32 v230, v230
    buffer_load_dwordx4 v[196:199], v12, s[20:23], s41 offen sc1
    v_fma_f32 v228, v228, v222, v222
    v_cvt_pk_bf16_f32 v253, v226, v227
    v_exp_f32 v231, v231
    v_fma_f32 v229, v229, v222, v222
    v_rcp_f32 v228, v228
    v_rcp_f32 v229, v229
    v_mul_f32 v228, v156, v228
    v_mul_f32 v229, v157, v229
    v_fma_f32 v230, v230, v222, v222
    v_cvt_pk_bf16_f32 v254, v228, v229
    v_fma_f32 v231, v231, v222, v222
    v_rcp_f32 v230, v230
    v_rcp_f32 v231, v231
    v_mul_f32 v230, v158, v230
    v_mul_f32 v231, v159, v231
    v_add_u32 v230, 0x10000, v230
    v_cvt_pk_bf16_f32 v255, v231, v231
    v_alignbit_b32 v255, v255, v230, 16
    v_bfi_b32 v255, 1, s46, v255
    buffer_store_dwordx4 v[252:255], v13, s[20:23], 0 offen offset:1024 sc1
    v_add_u32 v2, 4096, v12
    s_setprio 0
    v_bfe_u32 v248, v1, 1, 2
    v_mul_u32_u24 v248, 320, v248
    v_lshrrev_b32 v249, 3, v1
    v_lshl_add_u32 v248, v249, 4, v248
    v_and_b32 v249, 1, v1
    v_lshl_add_u32 v248, v249, 3, v248
    s_mul_i32 s60, s58, 1280
    s_add_u32 s60, s60, 24576
    v_add_u32 v248, s60, v248
    v_lshrrev_b32 v10, 4, v1
    v_lshlrev_b32 v9, 4, v1
    v_lshl_add_u32 v9, v10, 6, v9
    s_mul_i32 s60, s58, 10240
    s_add_u32 s60, s60, 24576
    v_add_u32 v9, s60, v9
    s_waitcnt lgkmcnt(0)
    s_barrier
    ds_write_b128 v9, v[128:131] offset:0
    ds_write_b128 v9, v[132:135] offset:1280
    ds_write_b128 v9, v[136:139] offset:2560
    ds_write_b128 v9, v[140:143] offset:3840
    v_lshrrev_b32 v249, 5, v1
    s_lshl_b32 s60, s58, 2
    v_add_u32 v249, s60, v249
    v_mul_u32_u24 v249, 114688, v249
    v_and_b32 v250, 31, v1
    v_lshl_add_u32 v249, v250, 4, v249
    v_mov_b32 v232, 73472
    s_lshl_b32 s60, s56, 9
    s_add_u32 s60, s60, 16777216
    s_waitcnt vmcnt(12)
    s_waitcnt lgkmcnt(0)
    s_barrier
    ds_read_b64 v[200:201], v248 offset:0
    ds_read_b64 v[202:203], v248 offset:10240
    ds_read_b64 v[204:205], v248 offset:20480
    ds_read_b64 v[206:207], v248 offset:30720
    ds_read_b64 v[208:209], v248 offset:128
    ds_read_b64 v[210:211], v248 offset:10368
    ds_read_b64 v[212:213], v248 offset:20608
    ds_read_b64 v[214:215], v248 offset:30848
    ds_read_b64 v[216:217], v248 offset:5120
    ds_read_b64 v[218:219], v248 offset:15360
    ds_read_b64 v[220:221], v248 offset:25600
    ds_read_b64 v[222:223], v248 offset:35840
    ds_read_b64 v[224:225], v248 offset:5248
    ds_read_b64 v[226:227], v248 offset:15488
    ds_read_b64 v[228:229], v248 offset:25728
    ds_read_b64 v[230:231], v248 offset:35968
    s_waitcnt lgkmcnt(14)
    v_add_f32 v200, v200, v202
    s_waitcnt lgkmcnt(12)
    v_add_f32 v204, v204, v206
    v_add_f32 v201, v201, v203
    v_add_f32 v205, v205, v207
    v_mov_b32 v207, s39
    v_cvt_pk_bf16_f32 v206, v201, v205
    v_cvt_pk_bf16_f32 v204, v200, v204
    v_mov_b32 v205, s39
    buffer_store_dwordx4 v[204:207], v249, s[20:23], s60 offen sc1
    s_add_u32 s60, s60, 229376
    s_waitcnt lgkmcnt(10)
    v_add_f32 v208, v208, v210
    s_waitcnt lgkmcnt(8)
    v_add_f32 v212, v212, v214
    v_add_f32 v209, v209, v211
    v_add_f32 v213, v213, v215
    v_mov_b32 v215, s39
    v_cvt_pk_bf16_f32 v214, v209, v213
    v_cvt_pk_bf16_f32 v212, v208, v212
    v_mov_b32 v213, s39
    buffer_store_dwordx4 v[212:215], v249, s[20:23], s60 offen sc1
    s_add_u32 s60, s60, 1605632
    s_waitcnt lgkmcnt(6)
    v_add_f32 v216, v216, v218
    s_waitcnt lgkmcnt(4)
    v_add_f32 v220, v220, v222
    v_add_f32 v217, v217, v219
    v_add_f32 v221, v221, v223
    v_mov_b32 v223, s39
    v_cvt_pk_bf16_f32 v222, v217, v221
    v_cvt_pk_bf16_f32 v220, v216, v220
    v_mov_b32 v221, s39
    buffer_store_dwordx4 v[220:223], v249, s[20:23], s60 offen sc1
    s_add_u32 s60, s60, 229376
    s_waitcnt lgkmcnt(2)
    v_add_f32 v224, v224, v226
    s_waitcnt lgkmcnt(0)
    v_add_f32 v228, v228, v230
    v_add_f32 v225, v225, v227
    v_add_f32 v229, v229, v231
    v_mov_b32 v231, s39
    v_cvt_pk_bf16_f32 v230, v225, v229
    v_cvt_pk_bf16_f32 v228, v224, v228
    v_mov_b32 v229, s39
    buffer_store_dwordx4 v[228:231], v249, s[20:23], s60 offen sc1
    s_mov_b64 exec, 1
    v_mov_b32 v233, 1
    ds_add_u32 v232, v233 offset:244
    s_mov_b64 exec, -1
    s_setprio 1
    s_waitcnt vmcnt(15)
    v_perm_b32 v235, v163, v160, s36
    v_and_b32 v235, 0x101, v235
    v_and_b32 v160, -2, v160
    v_cmp_ne_u32 vcc, s37, v235
    v_and_b32 v163, -2, v163
    s_nop 1
    s_cbranch_vccnz L_rtH0
L_bkH0:
    v_mfma_f32_32x32x16_bf16 v[128:143], v[160:163], v[16:19], 0
    s_waitcnt vmcnt(14)
    v_perm_b32 v235, v167, v164, s36
    v_and_b32 v235, 0x101, v235
    v_and_b32 v164, -2, v164
    v_cmp_ne_u32 vcc, s37, v235
    v_and_b32 v167, -2, v167
    v_mfma_f32_32x32x16_bf16 v[144:159], v[160:163], v[20:23], 0
    buffer_load_dwordx4 v[160:163], v12, s[20:23], s43 offen sc1
    s_cbranch_vccnz L_rtH1
L_bkH1:
    v_mfma_f32_32x32x16_bf16 v[128:143], v[164:167], v[24:27], v[128:143]
    s_waitcnt vmcnt(14)
    v_perm_b32 v235, v171, v168, s36
    v_and_b32 v235, 0x101, v235
    v_and_b32 v168, -2, v168
    v_cmp_ne_u32 vcc, s37, v235
    v_and_b32 v171, -2, v171
    v_mfma_f32_32x32x16_bf16 v[144:159], v[164:167], v[28:31], v[144:159]
    buffer_load_dwordx4 v[164:167], v12, s[20:23], s44 offen sc1
    s_cbranch_vccnz L_rtH2
L_bkH2:
    v_mfma_f32_32x32x16_bf16 v[128:143], v[168:171], v[32:35], v[128:143]
    s_waitcnt vmcnt(14)
    v_perm_b32 v235, v175, v172, s36
    v_and_b32 v235, 0x101, v235
    v_and_b32 v172, -2, v172
    v_cmp_ne_u32 vcc, s37, v235
    v_and_b32 v175, -2, v175
    v_mfma_f32_32x32x16_bf16 v[144:159], v[168:171], v[36:39], v[144:159]
    buffer_load_dwordx4 v[168:171], v12, s[20:23], s0 offen sc1
    s_cbranch_vccnz L_rtH3
L_bkH3:
    v_mfma_f32_32x32x16_bf16 v[128:143], v[172:175], v[40:43], v[128:143]
    s_waitcnt vmcnt(14)
    v_perm_b32 v235, v179, v176, s36
    v_and_b32 v235, 0x101, v235
    v_and_b32 v176, -2, v176
    v_cmp_ne_u32 vcc, s37, v235
    v_and_b32 v179, -2, v179
    v_mfma_f32_32x32x16_bf16 v[144:159], v[172:175], v[44:47], v[144:159]
    buffer_load_dwordx4 v[172:175], v12, s[20:23], s1 offen sc1
    s_cbranch_vccnz L_rtH4
L_bkH4:
    v_mfma_f32_32x32x16_bf16 v[128:143], v[176:179], v[48:51], v[128:143]
    s_waitcnt vmcnt(14)
    v_perm_b32 v235, v183, v180, s36
    v_and_b32 v235, 0x101, v235
    v_and_b32 v180, -2, v180
    v_cmp_ne_u32 vcc, s37, v235
    v_and_b32 v183, -2, v183
    v_mfma_f32_32x32x16_bf16 v[144:159], v[176:179], v[52:55], v[144:159]
    s_setprio 0
    buffer_load_dwordx4 v[176:179], v2, s[20:23], s48 offen sc1
    s_cbranch_vccnz L_rtH5
L_bkH5:
    v_mfma_f32_32x32x16_bf16 v[128:143], v[180:183], v[56:59], v[128:143]
    v_bfe_u32 v10, v1, 1, 4
    v_and_b32 v14, 1, v1
    v_lshl_add_u32 v10, v14, 4, v10
    s_and_b32 s60, s3, 1
    s_waitcnt vmcnt(14)
    v_perm_b32 v235, v187, v184, s36
    v_and_b32 v235, 0x101, v235
    v_and_b32 v184, -2, v184
    v_cmp_ne_u32 vcc, s37, v235
    v_and_b32 v187, -2, v187
    v_mfma_f32_32x32x16_bf16 v[144:159], v[180:183], v[60:63], v[144:159]
    s_lshl_b32 s60, s60, 3
    s_andn2_b32 s61, s3, 1
    s_add_u32 s60, s60, s61
    v_lshrrev_b32 v13, 5, v1
    s_setprio 1
    buffer_load_dwordx4 v[180:183], v2, s[20:23], s49 offen sc1
    s_cbranch_vccnz L_rtH6
L_bkH6:
    v_mfma_f32_32x32x16_bf16 v[128:143], v[184:187], v[64:67], v[128:143]
    v_add_u32 v13, s60, v13
    v_mul_u32_u24 v10, 272, v10
    v_lshl_add_u32 v10, v13, 4, v10
    s_and_b32 s60, s3, 3
    s_waitcnt vmcnt(13)
    v_perm_b32 v235, v191, v188, s36
    v_and_b32 v235, 0x101, v235
    v_and_b32 v188, -2, v188
    v_cmp_ne_u32 vcc, s37, v235
    v_and_b32 v191, -2, v191
    v_mfma_f32_32x32x16_bf16 v[144:159], v[184:187], v[68:71], v[144:159]
    s_lshl_b32 s60, s60, 13
    s_add_u32 s61, s60, 24576
    v_lshl_add_u32 v13, v1, 4, s61
    s_lshr_b32 s62, s3, 1
    s_setprio 0
    buffer_load_dwordx4 v[184:187], v2, s[20:23], s50 offen sc1
    s_cbranch_vccnz L_rtH7
L_bkH7:
    v_mfma_f32_32x32x16_bf16 v[128:143], v[188:191], v[72:75], v[128:143]
    s_lshl_b32 s62, s62, 11
    s_xor_b32 s61, s60, 0x4000
    s_add_u32 s61, s61, s62
    s_add_u32 s61, s61, 24576
    s_waitcnt vmcnt(13)
    v_perm_b32 v235, v195, v192, s36
    v_and_b32 v235, 0x101, v235
    v_and_b32 v192, -2, v192
    v_cmp_ne_u32 vcc, s37, v235
    v_and_b32 v195, -2, v195
    v_mfma_f32_32x32x16_bf16 v[144:159], v[188:191], v[76:79], v[144:159]
    v_lshl_add_u32 v14, v1, 4, s61
    s_and_b32 s61, s60, 0x2000
    s_add_u32 s61, s61, s62
    s_add_u32 s61, s61, 81920
    s_setprio 1
    buffer_load_dwordx4 v[188:191], v2, s[20:23], s51 offen sc1
    s_cbranch_vccnz L_rtH8
L_bkH8:
    v_mfma_f32_32x32x16_bf16 v[128:143], v[192:195], v[80:83], v[128:143]
    v_lshl_add_u32 v15, v1, 4, s61
    s_waitcnt vmcnt(13)
    v_perm_b32 v235, v199, v196, s36
    v_and_b32 v235, 0x101, v235
    v_and_b32 v196, -2, v196
    v_cmp_ne_u32 vcc, s37, v235
    v_and_b32 v199, -2, v199
    v_mfma_f32_32x32x16_bf16 v[144:159], v[192:195], v[84:87], v[144:159]
    s_setprio 0
    buffer_load_dwordx4 v[192:195], v2, s[20:23], s52 offen sc1
    s_cbranch_vccnz L_rtH9
L_bkH9:
    v_mfma_f32_32x32x16_bf16 v[128:143], v[196:199], v[88:91], v[128:143]
    s_waitcnt vmcnt(8)
    v_perm_b32 v235, v163, v160, s36
    v_and_b32 v235, 0x101, v235
    v_and_b32 v160, -2, v160
    v_cmp_ne_u32 vcc, s37, v235
    v_and_b32 v163, -2, v163
    v_mfma_f32_32x32x16_bf16 v[144:159], v[196:199], v[92:95], v[144:159]
    s_setprio 1
    buffer_load_dwordx4 v[196:199], v2, s[20:23], s53 offen sc1
    s_cbranch_vccnz L_rtH10
L_bkH10:
    v_mfma_f32_32x32x16_bf16 v[128:143], v[160:163], v[96:99], v[128:143]
    s_waitcnt vmcnt(8)
    v_perm_b32 v235, v167, v164, s36
    v_and_b32 v235, 0x101, v235
    v_and_b32 v164, -2, v164
    v_cmp_ne_u32 vcc, s37, v235
    v_and_b32 v167, -2, v167
    v_mfma_f32_32x32x16_bf16 v[144:159], v[160:163], v[100:103], v[144:159]
    s_setprio 0
    buffer_load_dwordx4 v[160:163], v2, s[20:23], s96 offen sc1
    s_cbranch_vccnz L_rtH11
L_bkH11:
    v_mfma_f32_32x32x16_bf16 v[128:143], v[164:167], v[104:107], v[128:143]
    ds_read_b64_tr_b16 v[200:201], v5 offset:8192
    ds_read_b64_tr_b16 v[202:203], v5 offset:9216
    ds_read_b64_tr_b16 v[204:205], v6 offset:8192
    ds_read_b64_tr_b16 v[206:207], v6 offset:9216
    s_waitcnt vmcnt(8)
    v_perm_b32 v235, v171, v168, s36
    v_and_b32 v235, 0x101, v235
    v_and_b32 v168, -2, v168
    v_cmp_ne_u32 vcc, s37, v235
    v_and_b32 v171, -2, v171
    v_mfma_f32_32x32x16_bf16 v[144:159], v[164:167], v[108:111], v[144:159]
    s_setprio 1
    buffer_load_dwordx4 v[164:167], v2, s[20:23], s97 offen sc1
    s_cbranch_vccnz L_rtH12
L_bkH12:
    v_mfma_f32_32x32x16_bf16 v[128:143], v[168:171], v[112:115], v[128:143]
    ds_read_b64_tr_b16 v[208:209], v3 offset:8192
    ds_read_b64_tr_b16 v[210:211], v3 offset:9216
    ds_read_b64_tr_b16 v[212:213], v4 offset:8192
    ds_read_b64_tr_b16 v[214:215], v4 offset:9216
    s_waitcnt vmcnt(8)
    v_perm_b32 v235, v175, v172, s36
    v_and_b32 v235, 0x101, v235
    v_and_b32 v172, -2, v172
    v_cmp_ne_u32 vcc, s37, v235
    v_and_b32 v175, -2, v175
    v_mfma_f32_32x32x16_bf16 v[144:159], v[168:171], v[116:119], v[144:159]
    s_setprio 0
    buffer_load_dwordx4 v[168:171], v2, s[20:23], s40 offen sc1
    s_cbranch_vccnz L_rtH13
L_bkH13:
    v_mfma_f32_32x32x16_bf16 v[128:143], v[172:175], v[120:123], v[128:143]
    ds_read_b64_tr_b16 v[216:217], v3 offset:16384
    ds_read_b64_tr_b16 v[218:219], v3 offset:17408
    ds_read_b64_tr_b16 v[220:221], v4 offset:16384
    ds_read_b64_tr_b16 v[222:223], v4 offset:17408
    s_waitcnt vmcnt(8)
    v_perm_b32 v235, v179, v176, s36
    v_and_b32 v235, 0x101, v235
    v_and_b32 v176, -2, v176
    v_cmp_ne_u32 vcc, s37, v235
    v_and_b32 v179, -2, v179
    v_mfma_f32_32x32x16_bf16 v[144:159], v[172:175], v[124:127], v[144:159]
    s_setprio 1
    buffer_load_dwordx4 v[172:175], v2, s[20:23], s41 offen sc1
    s_cbranch_vccnz L_rtH14
L_bkH14:
    s_waitcnt lgkmcnt(10)
    v_mfma_f32_32x32x16_bf16 v[128:143], v[176:179], v[200:203], v[128:143]
    ds_read_b64_tr_b16 v[224:225], v7 offset:8192
    ds_read_b64_tr_b16 v[226:227], v7 offset:9216
    ds_read_b64_tr_b16 v[228:229], v8 offset:8192
    ds_read_b64_tr_b16 v[230:231], v8 offset:9216
    s_waitcnt vmcnt(8)
    v_perm_b32 v235, v183, v180, s36
    v_and_b32 v235, 0x101, v235
    v_and_b32 v180, -2, v180
    v_cmp_ne_u32 vcc, s37, v235
    v_and_b32 v183, -2, v183
    s_waitcnt lgkmcnt(12)
    v_mfma_f32_32x32x16_bf16 v[144:159], v[176:179], v[204:207], v[144:159]
    s_setprio 0
    buffer_load_dwordx4 v[176:179], v2, s[20:23], s43 offen sc1
    s_cbranch_vccnz L_rtH15
L_bkH15:
    s_waitcnt lgkmcnt(10)
    v_mfma_f32_32x32x16_bf16 v[128:143], v[180:183], v[208:211], v[128:143]
    ds_read_b64_tr_b16 v[200:201], v7 offset:16384
    ds_read_b64_tr_b16 v[202:203], v7 offset:17408
    ds_read_b64_tr_b16 v[204:205], v8 offset:16384
    ds_read_b64_tr_b16 v[206:207], v8 offset:17408
    s_waitcnt vmcnt(8)
    v_perm_b32 v235, v187, v184, s36
    v_and_b32 v235, 0x101, v235
    v_and_b32 v184, -2, v184
    v_cmp_ne_u32 vcc, s37, v235
    v_and_b32 v187, -2, v187
    s_waitcnt lgkmcnt(12)
    v_mfma_f32_32x32x16_bf16 v[144:159], v[180:183], v[212:215], v[144:159]
    s_setprio 1
    buffer_load_dwordx4 v[180:183], v2, s[20:23], s44 offen sc1
    s_cbranch_vccnz L_rtH16
L_bkH16:
    s_waitcnt lgkmcnt(10)
    v_mfma_f32_32x32x16_bf16 v[128:143], v[184:187], v[216:219], v[128:143]
    ds_read_b64_tr_b16 v[208:209], v7 offset:24576
    ds_read_b64_tr_b16 v[210:211], v7 offset:25600
    ds_read_b64_tr_b16 v[212:213], v8 offset:24576
    ds_read_b64_tr_b16 v[214:215], v8 offset:25600
    s_waitcnt vmcnt(8)
    v_perm_b32 v235, v191, v188, s36
    v_and_b32 v235, 0x101, v235
    v_and_b32 v188, -2, v188
    v_cmp_ne_u32 vcc, s37, v235
    v_and_b32 v191, -2, v191
    s_waitcnt lgkmcnt(12)
    v_mfma_f32_32x32x16_bf16 v[144:159], v[184:187], v[220:223], v[144:159]
    s_setprio 0
    buffer_load_dwordx4 v[184:187], v2, s[20:23], s0 offen sc1
    s_cbranch_vccnz L_rtH17
L_bkH17:
    s_waitcnt lgkmcnt(10)
    v_mfma_f32_32x32x16_bf16 v[128:143], v[188:191], v[224:227], v[128:143]
    ds_read_b64_tr_b16 v[216:217], v7 offset:32768
    ds_read_b64_tr_b16 v[218:219], v7 offset:33792
    ds_read_b64_tr_b16 v[220:221], v8 offset:32768
    ds_read_b64_tr_b16 v[222:223], v8 offset:33792
    s_waitcnt vmcnt(8)
    v_perm_b32 v235, v195, v192, s36
    v_and_b32 v235, 0x101, v235
    v_and_b32 v192, -2, v192
    v_cmp_ne_u32 vcc, s37, v235
    v_and_b32 v195, -2, v195
    s_waitcnt lgkmcnt(12)
    v_mfma_f32_32x32x16_bf16 v[144:159], v[188:191], v[228:231], v[144:159]
    s_setprio 1
    buffer_load_dwordx4 v[188:191], v2, s[20:23], s1 offen sc1
    s_cbranch_vccnz L_rtH18
L_bkH18:
    s_waitcnt lgkmcnt(10)
    v_mfma_f32_32x32x16_bf16 v[128:143], v[192:195], v[200:203], v[128:143]
    ds_read_b64_tr_b16 v[224:225], v7 offset:40960
    ds_read_b64_tr_b16 v[226:227], v7 offset:41984
    ds_read_b64_tr_b16 v[228:229], v8 offset:40960
    ds_read_b64_tr_b16 v[230:231], v8 offset:41984
    v_bfe_u32 v246, v1, 1, 4
    v_and_b32 v247, 1, v1
    v_lshl_add_u32 v246, v247, 4, v246
    s_and_b32 s60, s3, 1
    s_lshl_b32 s60, s60, 3
    s_andn2_b32 s61, s3, 1
    s_add_u32 s60, s60, s61
    v_lshrrev_b32 v245, 5, v1
    v_add_u32 v245, s60, v245
    s_lshl_b32 s60, s98, 6
    v_lshl_add_u32 v245, v245, 2, s60
    v_mul_u32_u24 v245, 896, v245
    s_lshl_b32 s60, s99, 7
    v_lshl_add_u32 v246, v246, 2, s60
    v_add_u32 v245, v245, v246
    buffer_load_dword v252, v245, s[8:11], 0 offen offset:0
    buffer_load_dword v253, v245, s[8:11], 0 offen offset:896
    buffer_load_dword v254, v245, s[8:11], 0 offen offset:1792
    buffer_load_dword v255, v245, s[8:11], 0 offen offset:2688
    v_and_b32 v246, 31, v1
    v_lshl_add_u32 v246, v246, 1, s60
    s_mov_b32 s32, s54
    s_and_b32 s33, s55, 0xffff
    s_mov_b32 s34, 896
    s_mov_b32 s35, 0x00020000
    buffer_load_ushort v244, v246, s[32:35], 0 offen
    buffer_load_ushort v247, v246, s[32:35], 0 offen offset:64
    s_waitcnt vmcnt(14)
    v_perm_b32 v235, v199, v196, s36
    v_and_b32 v235, 0x101, v235
    v_and_b32 v196, -2, v196
    v_cmp_ne_u32 vcc, s37, v235
    v_and_b32 v199, -2, v199
    s_waitcnt lgkmcnt(12)
    v_mfma_f32_32x32x16_bf16 v[144:159], v[192:195], v[204:207], v[144:159]
    s_setprio 0
    s_cbranch_vccnz L_rtH19
L_bkH19:
    s_waitcnt lgkmcnt(10)
    v_mfma_f32_32x32x16_bf16 v[128:143], v[196:199], v[208:211], v[128:143]
    ds_read_b64_tr_b16 v[200:201], v7 offset:49152
    ds_read_b64_tr_b16 v[202:203], v7 offset:50176
    ds_read_b64_tr_b16 v[204:205], v8 offset:49152
    ds_read_b64_tr_b16 v[206:207], v8 offset:50176
    s_waitcnt vmcnt(13)
    v_perm_b32 v235, v163, v160, s36
    v_and_b32 v235, 0x101, v235
    v_and_b32 v160, -2, v160
    v_cmp_ne_u32 vcc, s37, v235
    v_and_b32 v163, -2, v163
    s_waitcnt lgkmcnt(12)
    v_mfma_f32_32x32x16_bf16 v[144:159], v[196:199], v[212:215], v[144:159]
    s_setprio 1
    s_cbranch_vccnz L_rtH20
L_bkH20:
    s_waitcnt lgkmcnt(10)
    v_mfma_f32_32x32x16_bf16 v[128:143], v[160:163], v[216:219], v[128:143]
    ds_read_b64_tr_b16 v[208:209], v7 offset:57344
    ds_read_b64_tr_b16 v[210:211], v7 offset:58368
    ds_read_b64_tr_b16 v[212:213], v8 offset:57344
    ds_read_b64_tr_b16 v[214:215], v8 offset:58368
    s_waitcnt vmcnt(12)
    v_perm_b32 v235, v167, v164, s36
    v_and_b32 v235, 0x101, v235
    v_and_b32 v164, -2, v164
    v_cmp_ne_u32 vcc, s37, v235
    v_and_b32 v167, -2, v167
    s_waitcnt lgkmcnt(12)
    v_mfma_f32_32x32x16_bf16 v[144:159], v[160:163], v[220:223], v[144:159]
    s_setprio 0
    s_cbranch_vccnz L_rtH21
L_bkH21:
    s_waitcnt lgkmcnt(10)
    v_mfma_f32_32x32x16_bf16 v[128:143], v[164:167], v[224:227], v[128:143]
    ds_read_b64_tr_b16 v[216:217], v3 offset:0
    ds_read_b64_tr_b16 v[218:219], v3 offset:1024
    ds_read_b64_tr_b16 v[220:221], v4 offset:0
    ds_read_b64_tr_b16 v[222:223], v4 offset:1024
    s_waitcnt vmcnt(11)
    v_perm_b32 v235, v171, v168, s36
    v_and_b32 v235, 0x101, v235
    v_and_b32 v168, -2, v168
    v_cmp_ne_u32 vcc, s37, v235
    v_and_b32 v171, -2, v171
    s_waitcnt lgkmcnt(12)
    v_mfma_f32_32x32x16_bf16 v[144:159], v[164:167], v[228:231], v[144:159]
    v_mov_b32 v232, 73472
    s_mov_b64 exec, 1
    v_mov_b32 v233, 256
    ds_add_u32 v232, v233 offset:240
    s_mov_b64 exec, -1
    s_setprio 1
    s_cbranch_vccnz L_rtH22
L_bkH22:
    s_waitcnt lgkmcnt(11)
    v_mfma_f32_32x32x16_bf16 v[128:143], v[168:171], v[200:203], v[128:143]
    ds_read_b64_tr_b16 v[224:225], v7 offset:0
    ds_read_b64_tr_b16 v[226:227], v7 offset:1024
    ds_read_b64_tr_b16 v[228:229], v8 offset:0
    ds_read_b64_tr_b16 v[230:231], v8 offset:1024
    s_waitcnt vmcnt(10)
    v_perm_b32 v235, v175, v172, s36
    v_and_b32 v235, 0x101, v235
    v_and_b32 v172, -2, v172
    v_cmp_ne_u32 vcc, s37, v235
    v_and_b32 v175, -2, v175
    s_waitcnt lgkmcnt(13)
    v_mfma_f32_32x32x16_bf16 v[144:159], v[168:171], v[204:207], v[144:159]
    s_setprio 0
    s_cbranch_vccnz L_rtH23
L_bkH23:
    s_waitcnt lgkmcnt(11)
    v_mfma_f32_32x32x16_bf16 v[128:143], v[172:175], v[208:211], v[128:143]
    ds_read_b64_tr_b16 v[200:201], v5 offset:16384
    ds_read_b64_tr_b16 v[202:203], v5 offset:17408
    ds_read_b64_tr_b16 v[204:205], v6 offset:16384
    ds_read_b64_tr_b16 v[206:207], v6 offset:17408
    s_waitcnt vmcnt(9)
    v_perm_b32 v235, v179, v176, s36
    v_and_b32 v235, 0x101, v235
    v_and_b32 v176, -2, v176
    v_cmp_ne_u32 vcc, s37, v235
    v_and_b32 v179, -2, v179
    s_waitcnt lgkmcnt(13)
    v_mfma_f32_32x32x16_bf16 v[144:159], v[172:175], v[212:215], v[144:159]
    s_setprio 1
    s_cbranch_vccnz L_rtH24
L_bkH24:
    s_waitcnt lgkmcnt(11)
    v_mfma_f32_32x32x16_bf16 v[128:143], v[176:179], v[216:219], v[128:143]
    ds_read_b64_tr_b16 v[208:209], v5 offset:0
    ds_read_b64_tr_b16 v[210:211], v5 offset:1024
    ds_read_b64_tr_b16 v[212:213], v6 offset:0
    ds_read_b64_tr_b16 v[214:215], v6 offset:1024
    s_waitcnt vmcnt(8)
    v_perm_b32 v235, v183, v180, s36
    v_and_b32 v235, 0x101, v235
    v_and_b32 v180, -2, v180
    v_cmp_ne_u32 vcc, s37, v235
    v_and_b32 v183, -2, v183
    s_waitcnt lgkmcnt(13)
    v_mfma_f32_32x32x16_bf16 v[144:159], v[176:179], v[220:223], v[144:159]
    s_setprio 0
    s_cbranch_vccnz L_rtH25
L_bkH25:
    s_waitcnt lgkmcnt(10)
    v_mfma_f32_32x32x16_bf16 v[128:143], v[180:183], v[224:227], v[128:143]
    s_waitcnt vmcnt(7)
    v_perm_b32 v235, v187, v184, s36
    v_and_b32 v235, 0x101, v235
    v_and_b32 v184, -2, v184
    v_cmp_ne_u32 vcc, s37, v235
    v_and_b32 v187, -2, v187
    s_waitcnt lgkmcnt(8)
    v_mfma_f32_32x32x16_bf16 v[144:159], v[180:183], v[228:231], v[144:159]
    s_setprio 1
    s_cbranch_vccnz L_rtH26
L_bkH26:
    s_waitcnt lgkmcnt(6)
    v_mfma_f32_32x32x16_bf16 v[128:143], v[184:187], v[200:203], v[128:143]
    s_waitcnt vmcnt(6)
    v_perm_b32 v235, v191, v188, s36
    v_and_b32 v235, 0x101, v235
    v_and_b32 v188, -2, v188
    v_cmp_ne_u32 vcc, s37, v235
    v_and_b32 v191, -2, v191
    s_waitcnt lgkmcnt(4)
    v_mfma_f32_32x32x16_bf16 v[144:159], v[184:187], v[204:207], v[144:159]
    ds_read_b32 v233, v232 offset:244
    s_setprio 0
    s_cbranch_vccnz L_rtH27
L_bkH27:
    s_waitcnt lgkmcnt(3)
    v_mfma_f32_32x32x16_bf16 v[128:143], v[188:191], v[208:211], v[128:143]
    s_waitcnt lgkmcnt(1)
    v_mfma_f32_32x32x16_bf16 v[144:159], v[188:191], v[212:215], v[144:159]
    s_setprio 1
    s_waitcnt lgkmcnt(0)
    v_readfirstlane_b32 s62, v233
    s_nop 0
    s_cmp_ge_u32 s62, 4
    s_cbranch_scc1 L_ldh3
    v_mov_b32 v232, 73472
    s_mov_b32 s63, 0
L_lsh3:
    ds_read_b32 v233, v232 offset:244
    s_waitcnt lgkmcnt(0)
    v_readfirstlane_b32 s62, v233
    s_nop 0
    s_cmp_ge_u32 s62, 4
    s_cbranch_scc1 L_ldh3
    s_add_u32 s63, s63, 1
    s_cmp_lt_u32 s63, 200000
    s_cbranch_scc1 L_lsh3
L_ldh3:
    s_waitcnt vmcnt(5)
    v_lshlrev_b32 v192, 16, v252
    v_and_b32 v196, 0xffff0000, v252
    s_waitcnt vmcnt(4)
    v_lshlrev_b32 v193, 16, v253
    v_and_b32 v197, 0xffff0000, v253
    s_waitcnt vmcnt(3)
    v_lshlrev_b32 v194, 16, v254
    v_and_b32 v198, 0xffff0000, v254
    s_waitcnt vmcnt(2)
    v_lshlrev_b32 v195, 16, v255
    v_and_b32 v199, 0xffff0000, v255
    s_mov_b32 s62, 0xbfb8aa3b
    s_waitcnt vmcnt(1)
    v_lshlrev_b32 v244, 16, v244
    s_waitcnt vmcnt(0)
    v_lshlrev_b32 v247, 16, v247
    v_mul_f32 v244, s62, v244
    v_mul_f32 v247, s62, v247
    s_bitcmp1_b32 s3, 1
    s_cbranch_scc1 L_pw11
    ds_write_b128 v13, v[128:131] offset:0
    ds_write_b128 v13, v[132:135] offset:2048
    ds_write_b128 v13, v[140:143] offset:6144
    ds_write_b128 v13, v[144:147] offset:1024
    ds_write_b128 v13, v[148:151] offset:3072
    ds_write_b128 v13, v[156:159] offset:7168
    v_fma_f32 v160, v136, s62, v244
    v_fma_f32 v161, v137, s62, v244
    v_fma_f32 v162, v138, s62, v244
    v_fma_f32 v163, v139, s62, v244
    v_fma_f32 v164, v152, s62, v247
    v_fma_f32 v165, v153, s62, v247
    v_fma_f32 v166, v154, s62, v247
    v_fma_f32 v167, v155, s62, v247
    s_branch L_pw21
L_pw11:
    ds_write_b128 v13, v[128:131] offset:0
    ds_write_b128 v13, v[132:135] offset:2048
    ds_write_b128 v13, v[136:139] offset:4096
    ds_write_b128 v13, v[144:147] offset:1024
    ds_write_b128 v13, v[148:151] offset:3072
    ds_write_b128 v13, v[152:155] offset:5120
    v_fma_f32 v160, v140, s62, v244
    v_fma_f32 v161, v141, s62, v244
    v_fma_f32 v162, v142, s62, v244
    v_fma_f32 v163, v143, s62, v244
    v_fma_f32 v164, v156, s62, v247
    v_fma_f32 v165, v157, s62, v247
    v_fma_f32 v166, v158, s62, v247
    v_fma_f32 v167, v159, s62, v247
L_pw21:
    s_mov_b32 vcc_lo, 0x55555555
    s_mov_b32 vcc_hi, 0x55555555
L_fin:
    s_waitcnt lgkmcnt(0)
    s_barrier
    ds_read_b128 v[168:171], v14 offset:0
    ds_read_b128 v[172:175], v14 offset:1024
    ds_read_b128 v[176:179], v15 offset:0
    ds_read_b128 v[180:183], v15 offset:1024
    ds_read_b128 v[184:187], v15 offset:16384
    ds_read_b128 v[188:191], v15 offset:17408
    ds_read_b128 v[232:235], v10 offset:59520
    s_waitcnt lgkmcnt(5)
    v_fmac_f32 v164, s62, v172
    v_fmac_f32 v165, s62, v173
    v_fmac_f32 v166, s62, v174
    v_fmac_f32 v167, s62, v175
    v_fmac_f32 v160, s62, v168
    v_fmac_f32 v161, s62, v169
    v_fmac_f32 v162, s62, v170
    v_fmac_f32 v163, s62, v171
    s_waitcnt lgkmcnt(3)
    v_fmac_f32 v164, s62, v180
    v_fmac_f32 v165, s62, v181
    v_fmac_f32 v166, s62, v182
    v_fmac_f32 v167, s62, v183
    v_fmac_f32 v160, s62, v176
    v_fmac_f32 v161, s62, v177
    v_fmac_f32 v162, s62, v178
    v_fmac_f32 v163, s62, v179
    s_waitcnt lgkmcnt(1)
    v_fmac_f32 v164, s62, v188
    v_fmac_f32 v165, s62, v189
    v_fmac_f32 v166, s62, v190
    v_fmac_f32 v167, s62, v191
    v_fmac_f32 v160, s62, v184
    v_fmac_f32 v161, s62, v185
    v_fmac_f32 v162, s62, v186
    v_fmac_f32 v163, s62, v187
    v_cndmask_b32_dpp v168, v164, v160, vcc quad_perm:[1,0,3,2] row_mask:0xf bank_mask:0xf
    v_cndmask_b32_dpp v169, v165, v161, vcc quad_perm:[1,0,3,2] row_mask:0xf bank_mask:0xf
    v_cndmask_b32_dpp v170, v166, v162, vcc quad_perm:[1,0,3,2] row_mask:0xf bank_mask:0xf
    v_cndmask_b32_dpp v171, v167, v163, vcc quad_perm:[1,0,3,2] row_mask:0xf bank_mask:0xf
    s_not_b64 vcc, vcc
    v_cndmask_b32_dpp v172, v160, v164, vcc quad_perm:[1,0,3,2] row_mask:0xf bank_mask:0xf
    v_cndmask_b32_dpp v173, v161, v165, vcc quad_perm:[1,0,3,2] row_mask:0xf bank_mask:0xf
    v_cndmask_b32_dpp v174, v162, v166, vcc quad_perm:[1,0,3,2] row_mask:0xf bank_mask:0xf
    v_cndmask_b32_dpp v175, v163, v167, vcc quad_perm:[1,0,3,2] row_mask:0xf bank_mask:0xf
    v_exp_f32 v160, v168
    s_waitcnt lgkmcnt(0)
    v_lshlrev_b32 v176, 16, v232
    v_exp_f32 v161, v169
    v_and_b32 v180, 0xffff0000, v232
    v_exp_f32 v162, v170
    v_lshlrev_b32 v177, 16, v233
    v_exp_f32 v163, v171
    v_and_b32 v181, 0xffff0000, v233
    v_exp_f32 v164, v172
    v_lshlrev_b32 v178, 16, v234
    v_exp_f32 v165, v173
    v_and_b32 v182, 0xffff0000, v234
    v_exp_f32 v166, v174
    v_lshlrev_b32 v179, 16, v235
    v_exp_f32 v167, v175
    v_and_b32 v183, 0xffff0000, v235
    v_fma_f32 v160, v160, s62, s62
    v_fma_f32 v161, v161, s62, s62
    v_fma_f32 v162, v162, s62, s62
    v_fma_f32 v163, v163, s62, s62
    v_fma_f32 v164, v164, s62, s62
    v_fma_f32 v165, v165, s62, s62
    v_fma_f32 v166, v166, s62, s62
    v_fma_f32 v167, v167, s62, s62
    v_rcp_f32 v160, v160
    v_mul_f32 v168, v168, v176
    v_rcp_f32 v164, v164
    v_mul_f32 v172, v172, v180
    v_rcp_f32 v161, v161
    v_mul_f32 v169, v169, v177
    v_rcp_f32 v165, v165
    v_mul_f32 v173, v173, v181
    v_fmac_f32 v192, v160, v168
    v_fmac_f32 v196, v164, v172
    v_cvt_pk_bf16_f32 v192, v192, v196
    buffer_store_dword v192, v245, s[24:27], 0 offen offset:0
    v_rcp_f32 v162, v162
    v_mul_f32 v170, v170, v178
    v_rcp_f32 v166, v166
    v_mul_f32 v174, v174, v182
    v_fmac_f32 v193, v161, v169
    v_fmac_f32 v197, v165, v173
    v_cvt_pk_bf16_f32 v193, v193, v197
    buffer_store_dword v193, v245, s[24:27], 0 offen offset:896
    v_rcp_f32 v163, v163
    v_mul_f32 v171, v171, v179
    v_rcp_f32 v167, v167
    v_mul_f32 v175, v175, v183
    v_fmac_f32 v194, v162, v170
    v_fmac_f32 v198, v166, v174
    v_cvt_pk_bf16_f32 v194, v194, v198
    buffer_store_dword v194, v245, s[24:27], 0 offen offset:1792
    v_fmac_f32 v195, v163, v171
    v_fmac_f32 v199, v167, v175
    v_cvt_pk_bf16_f32 v195, v195, v199
    buffer_store_dword v195, v245, s[24:27], 0 offen offset:2688
    s_endpgm
L_rtL0:
    s_add_u32 s47, s47, 1
    s_cmp_ge_u32 s47, 4096
    s_cbranch_scc1 L_bkL0
    buffer_load_dwordx4 v[160:163], v12, s[20:23], s48 offen sc1
    buffer_load_dwordx4 v[164:167], v12, s[20:23], s49 offen sc1
    buffer_load_dwordx4 v[168:171], v12, s[20:23], s50 offen sc1
    buffer_load_dwordx4 v[172:175], v12, s[20:23], s51 offen sc1
    buffer_load_dwordx4 v[176:179], v12, s[20:23], s52 offen sc1
    buffer_load_dwordx4 v[180:183], v12, s[20:23], s53 offen sc1
    buffer_load_dwordx4 v[184:187], v12, s[20:23], s96 offen sc1
    buffer_load_dwordx4 v[188:191], v12, s[20:23], s97 offen sc1
    buffer_load_dwordx4 v[192:195], v12, s[20:23], s40 offen sc1
    buffer_load_dwordx4 v[196:199], v12, s[20:23], s41 offen sc1
    s_waitcnt vmcnt(0)
    v_perm_b32 v235, v163, v160, s36
    v_and_b32 v235, 0x101, v235
    v_and_b32 v160, -2, v160
    v_cmp_ne_u32 vcc, s37, v235
    v_and_b32 v163, -2, v163
    s_nop 1
    s_cbranch_vccnz L_rtL0
    s_branch L_bkL0
L_rtL1:
    s_add_u32 s47, s47, 1
    s_cmp_ge_u32 s47, 4096
    s_cbranch_scc1 L_bkL1
    buffer_load_dwordx4 v[164:167], v12, s[20:23], s49 offen sc1
    buffer_load_dwordx4 v[168:171], v12, s[20:23], s50 offen sc1
    buffer_load_dwordx4 v[172:175], v12, s[20:23], s51 offen sc1
    buffer_load_dwordx4 v[176:179], v12, s[20:23], s52 offen sc1
    buffer_load_dwordx4 v[180:183], v12, s[20:23], s53 offen sc1
    buffer_load_dwordx4 v[184:187], v12, s[20:23], s96 offen sc1
    buffer_load_dwordx4 v[188:191], v12, s[20:23], s97 offen sc1
    buffer_load_dwordx4 v[192:195], v12, s[20:23], s40 offen sc1
    buffer_load_dwordx4 v[196:199], v12, s[20:23], s41 offen sc1
    buffer_load_dwordx4 v[160:163], v12, s[20:23], s43 offen sc1
    s_waitcnt vmcnt(0)
    v_perm_b32 v235, v167, v164, s36
    v_and_b32 v235, 0x101, v235
    v_and_b32 v164, -2, v164
    v_cmp_ne_u32 vcc, s37, v235
    v_and_b32 v167, -2, v167
    s_nop 1
    s_cbranch_vccnz L_rtL1
    s_branch L_bkL1
L_rtL2:
    s_add_u32 s47, s47, 1
    s_cmp_ge_u32 s47, 4096
    s_cbranch_scc1 L_bkL2
    buffer_load_dwordx4 v[168:171], v12, s[20:23], s50 offen sc1
    buffer_load_dwordx4 v[172:175], v12, s[20:23], s51 offen sc1
    buffer_load_dwordx4 v[176:179], v12, s[20:23], s52 offen sc1
    buffer_load_dwordx4 v[180:183], v12, s[20:23], s53 offen sc1
    buffer_load_dwordx4 v[184:187], v12, s[20:23], s96 offen sc1
    buffer_load_dwordx4 v[188:191], v12, s[20:23], s97 offen sc1
    buffer_load_dwordx4 v[192:195], v12, s[20:23], s40 offen sc1
    buffer_load_dwordx4 v[196:199], v12, s[20:23], s41 offen sc1
    buffer_load_dwordx4 v[160:163], v12, s[20:23], s43 offen sc1
    buffer_load_dwordx4 v[164:167], v12, s[20:23], s44 offen sc1
    s_waitcnt vmcnt(0)
    v_perm_b32 v235, v171, v168, s36
    v_and_b32 v235, 0x101, v235
    v_and_b32 v168, -2, v168
    v_cmp_ne_u32 vcc, s37, v235
    v_and_b32 v171, -2, v171
    s_nop 1
    s_cbranch_vccnz L_rtL2
    s_branch L_bkL2
L_rtL3:
    s_add_u32 s47, s47, 1
    s_cmp_ge_u32 s47, 4096
    s_cbranch_scc1 L_bkL3
    buffer_load_dwordx4 v[172:175], v12, s[20:23], s51 offen sc1
    buffer_load_dwordx4 v[176:179], v12, s[20:23], s52 offen sc1
    buffer_load_dwordx4 v[180:183], v12, s[20:23], s53 offen sc1
    buffer_load_dwordx4 v[184:187], v12, s[20:23], s96 offen sc1
    buffer_load_dwordx4 v[188:191], v12, s[20:23], s97 offen sc1
    buffer_load_dwordx4 v[192:195], v12, s[20:23], s40 offen sc1
    buffer_load_dwordx4 v[196:199], v12, s[20:23], s41 offen sc1
    buffer_load_dwordx4 v[160:163], v12, s[20:23], s43 offen sc1
    buffer_load_dwordx4 v[164:167], v12, s[20:23], s44 offen sc1
    buffer_load_dwordx4 v[168:171], v12, s[20:23], s0 offen sc1
    s_waitcnt vmcnt(0)
    v_perm_b32 v235, v175, v172, s36
    v_and_b32 v235, 0x101, v235
    v_and_b32 v172, -2, v172
    v_cmp_ne_u32 vcc, s37, v235
    v_and_b32 v175, -2, v175
    s_nop 1
    s_cbranch_vccnz L_rtL3
    s_branch L_bkL3
L_rtL4:
    s_add_u32 s47, s47, 1
    s_cmp_ge_u32 s47, 4096
    s_cbranch_scc1 L_bkL4
    buffer_load_dwordx4 v[176:179], v12, s[20:23], s52 offen sc1
    buffer_load_dwordx4 v[180:183], v12, s[20:23], s53 offen sc1
    buffer_load_dwordx4 v[184:187], v12, s[20:23], s96 offen sc1
    buffer_load_dwordx4 v[188:191], v12, s[20:23], s97 offen sc1
    buffer_load_dwordx4 v[192:195], v12, s[20:23], s40 offen sc1
    buffer_load_dwordx4 v[196:199], v12, s[20:23], s41 offen sc1
    buffer_load_dwordx4 v[160:163], v12, s[20:23], s43 offen sc1
    buffer_load_dwordx4 v[164:167], v12, s[20:23], s44 offen sc1
    buffer_load_dwordx4 v[168:171], v12, s[20:23], s0 offen sc1
    buffer_load_dwordx4 v[172:175], v12, s[20:23], s1 offen sc1
    s_waitcnt vmcnt(0)
    v_perm_b32 v235, v179, v176, s36
    v_and_b32 v235, 0x101, v235
    v_and_b32 v176, -2, v176
    v_cmp_ne_u32 vcc, s37, v235
    v_and_b32 v179, -2, v179
    s_nop 1
    s_cbranch_vccnz L_rtL4
    s_branch L_bkL4
L_rtL5:
    s_add_u32 s47, s47, 1
    s_cmp_ge_u32 s47, 4096
    s_cbranch_scc1 L_bkL5
    buffer_load_dwordx4 v[180:183], v12, s[20:23], s53 offen sc1
    buffer_load_dwordx4 v[184:187], v12, s[20:23], s96 offen sc1
    buffer_load_dwordx4 v[188:191], v12, s[20:23], s97 offen sc1
    buffer_load_dwordx4 v[192:195], v12, s[20:23], s40 offen sc1
    buffer_load_dwordx4 v[196:199], v12, s[20:23], s41 offen sc1
    buffer_load_dwordx4 v[160:163], v12, s[20:23], s43 offen sc1
    buffer_load_dwordx4 v[164:167], v12, s[20:23], s44 offen sc1
    buffer_load_dwordx4 v[168:171], v12, s[20:23], s0 offen sc1
    buffer_load_dwordx4 v[172:175], v12, s[20:23], s1 offen sc1
    buffer_load_dwordx4 v[176:179], v2, s[20:23], s48 offen sc1
    s_waitcnt vmcnt(0)
    v_perm_b32 v235, v183, v180, s36
    v_and_b32 v235, 0x101, v235
    v_and_b32 v180, -2, v180
    v_cmp_ne_u32 vcc, s37, v235
    v_and_b32 v183, -2, v183
    s_nop 1
    s_cbranch_vccnz L_rtL5
    s_branch L_bkL5
L_rtL6:
    s_add_u32 s47, s47, 1
    s_cmp_ge_u32 s47, 4096
    s_cbranch_scc1 L_bkL6
    buffer_load_dwordx4 v[184:187], v12, s[20:23], s96 offen sc1
    buffer_load_dwordx4 v[188:191], v12, s[20:23], s97 offen sc1
    buffer_load_dwordx4 v[192:195], v12, s[20:23], s40 offen sc1
    buffer_load_dwordx4 v[196:199], v12, s[20:23], s41 offen sc1
    buffer_load_dwordx4 v[160:163], v12, s[20:23], s43 offen sc1
    buffer_load_dwordx4 v[164:167], v12, s[20:23], s44 offen sc1
    buffer_load_dwordx4 v[168:171], v12, s[20:23], s0 offen sc1
    buffer_load_dwordx4 v[172:175], v12, s[20:23], s1 offen sc1
    buffer_load_dwordx4 v[176:179], v2, s[20:23], s48 offen sc1
    buffer_load_dwordx4 v[180:183], v2, s[20:23], s49 offen sc1
    s_waitcnt vmcnt(0)
    v_perm_b32 v235, v187, v184, s36
    v_and_b32 v235, 0x101, v235
    v_and_b32 v184, -2, v184
    v_cmp_ne_u32 vcc, s37, v235
    v_and_b32 v187, -2, v187
    s_nop 1
    s_cbranch_vccnz L_rtL6
    s_branch L_bkL6
L_rtL7:
    s_add_u32 s47, s47, 1
    s_cmp_ge_u32 s47, 4096
    s_cbranch_scc1 L_bkL7
    buffer_load_dwordx4 v[188:191], v12, s[20:23], s97 offen sc1
    buffer_load_dwordx4 v[192:195], v12, s[20:23], s40 offen sc1
    buffer_load_dwordx4 v[196:199], v12, s[20:23], s41 offen sc1
    buffer_load_dwordx4 v[160:163], v12, s[20:23], s43 offen sc1
    buffer_load_dwordx4 v[164:167], v12, s[20:23], s44 offen sc1
    buffer_load_dwordx4 v[168:171], v12, s[20:23], s0 offen sc1
    buffer_load_dwordx4 v[172:175], v12, s[20:23], s1 offen sc1
    buffer_load_dwordx4 v[176:179], v2, s[20:23], s48 offen sc1
    buffer_load_dwordx4 v[180:183], v2, s[20:23], s49 offen sc1
    buffer_load_dwordx4 v[184:187], v2, s[20:23], s50 offen sc1
    s_waitcnt vmcnt(0)
    v_perm_b32 v235, v191, v188, s36
    v_and_b32 v235, 0x101, v235
    v_and_b32 v188, -2, v188
    v_cmp_ne_u32 vcc, s37, v235
    v_and_b32 v191, -2, v191
    s_nop 1
    s_cbranch_vccnz L_rtL7
    s_branch L_bkL7
L_rtL8:
    s_add_u32 s47, s47, 1
    s_cmp_ge_u32 s47, 4096
    s_cbranch_scc1 L_bkL8
    buffer_load_dwordx4 v[192:195], v12, s[20:23], s40 offen sc1
    buffer_load_dwordx4 v[196:199], v12, s[20:23], s41 offen sc1
    buffer_load_dwordx4 v[160:163], v12, s[20:23], s43 offen sc1
    buffer_load_dwordx4 v[164:167], v12, s[20:23], s44 offen sc1
    buffer_load_dwordx4 v[168:171], v12, s[20:23], s0 offen sc1
    buffer_load_dwordx4 v[172:175], v12, s[20:23], s1 offen sc1
    buffer_load_dwordx4 v[176:179], v2, s[20:23], s48 offen sc1
    buffer_load_dwordx4 v[180:183], v2, s[20:23], s49 offen sc1
    buffer_load_dwordx4 v[184:187], v2, s[20:23], s50 offen sc1
    buffer_load_dwordx4 v[188:191], v2, s[20:23], s51 offen sc1
    s_waitcnt vmcnt(0)
    v_perm_b32 v235, v195, v192, s36
    v_and_b32 v235, 0x101, v235
    v_and_b32 v192, -2, v192
    v_cmp_ne_u32 vcc, s37, v235
    v_and_b32 v195, -2, v195
    s_nop 1
    s_cbranch_vccnz L_rtL8
    s_branch L_bkL8
L_rtL9:
    s_add_u32 s47, s47, 1
    s_cmp_ge_u32 s47, 4096
    s_cbranch_scc1 L_bkL9
    buffer_load_dwordx4 v[196:199], v12, s[20:23], s41 offen sc1
    buffer_load_dwordx4 v[160:163], v12, s[20:23], s43 offen sc1
    buffer_load_dwordx4 v[164:167], v12, s[20:23], s44 offen sc1
    buffer_load_dwordx4 v[168:171], v12, s[20:23], s0 offen sc1
    buffer_load_dwordx4 v[172:175], v12, s[20:23], s1 offen sc1
    buffer_load_dwordx4 v[176:179], v2, s[20:23], s48 offen sc1
    buffer_load_dwordx4 v[180:183], v2, s[20:23], s49 offen sc1
    buffer_load_dwordx4 v[184:187], v2, s[20:23], s50 offen sc1
    buffer_load_dwordx4 v[188:191], v2, s[20:23], s51 offen sc1
    buffer_load_dwordx4 v[192:195], v2, s[20:23], s52 offen sc1
    s_waitcnt vmcnt(0)
    v_perm_b32 v235, v199, v196, s36
    v_and_b32 v235, 0x101, v235
    v_and_b32 v196, -2, v196
    v_cmp_ne_u32 vcc, s37, v235
    v_and_b32 v199, -2, v199
    s_nop 1
    s_cbranch_vccnz L_rtL9
    s_branch L_bkL9
L_rtL10:
    s_add_u32 s47, s47, 1
    s_cmp_ge_u32 s47, 4096
    s_cbranch_scc1 L_bkL10
    buffer_load_dwordx4 v[160:163], v12, s[20:23], s43 offen sc1
    buffer_load_dwordx4 v[164:167], v12, s[20:23], s44 offen sc1
    buffer_load_dwordx4 v[168:171], v12, s[20:23], s0 offen sc1
    buffer_load_dwordx4 v[172:175], v12, s[20:23], s1 offen sc1
    buffer_load_dwordx4 v[176:179], v2, s[20:23], s48 offen sc1
    buffer_load_dwordx4 v[180:183], v2, s[20:23], s49 offen sc1
    buffer_load_dwordx4 v[184:187], v2, s[20:23], s50 offen sc1
    buffer_load_dwordx4 v[188:191], v2, s[20:23], s51 offen sc1
    buffer_load_dwordx4 v[192:195], v2, s[20:23], s52 offen sc1
    buffer_load_dwordx4 v[196:199], v2, s[20:23], s53 offen sc1
    s_waitcnt vmcnt(0)
    v_perm_b32 v235, v163, v160, s36
    v_and_b32 v235, 0x101, v235
    v_and_b32 v160, -2, v160
    v_cmp_ne_u32 vcc, s37, v235
    v_and_b32 v163, -2, v163
    s_nop 1
    s_cbranch_vccnz L_rtL10
    s_branch L_bkL10
L_rtL11:
    s_add_u32 s47, s47, 1
    s_cmp_ge_u32 s47, 4096
    s_cbranch_scc1 L_bkL11
    buffer_load_dwordx4 v[164:167], v12, s[20:23], s44 offen sc1
    buffer_load_dwordx4 v[168:171], v12, s[20:23], s0 offen sc1
    buffer_load_dwordx4 v[172:175], v12, s[20:23], s1 offen sc1
    buffer_load_dwordx4 v[176:179], v2, s[20:23], s48 offen sc1
    buffer_load_dwordx4 v[180:183], v2, s[20:23], s49 offen sc1
    buffer_load_dwordx4 v[184:187], v2, s[20:23], s50 offen sc1
    buffer_load_dwordx4 v[188:191], v2, s[20:23], s51 offen sc1
    buffer_load_dwordx4 v[192:195], v2, s[20:23], s52 offen sc1
    buffer_load_dwordx4 v[196:199], v2, s[20:23], s53 offen sc1
    buffer_load_dwordx4 v[160:163], v2, s[20:23], s96 offen sc1
    s_waitcnt vmcnt(0)
    v_perm_b32 v235, v167, v164, s36
    v_and_b32 v235, 0x101, v235
    v_and_b32 v164, -2, v164
    v_cmp_ne_u32 vcc, s37, v235
    v_and_b32 v167, -2, v167
    s_nop 1
    s_cbranch_vccnz L_rtL11
    s_branch L_bkL11
L_rtL12:
    s_add_u32 s47, s47, 1
    s_cmp_ge_u32 s47, 4096
    s_cbranch_scc1 L_bkL12
    buffer_load_dwordx4 v[168:171], v12, s[20:23], s0 offen sc1
    buffer_load_dwordx4 v[172:175], v12, s[20:23], s1 offen sc1
    buffer_load_dwordx4 v[176:179], v2, s[20:23], s48 offen sc1
    buffer_load_dwordx4 v[180:183], v2, s[20:23], s49 offen sc1
    buffer_load_dwordx4 v[184:187], v2, s[20:23], s50 offen sc1
    buffer_load_dwordx4 v[188:191], v2, s[20:23], s51 offen sc1
    buffer_load_dwordx4 v[192:195], v2, s[20:23], s52 offen sc1
    buffer_load_dwordx4 v[196:199], v2, s[20:23], s53 offen sc1
    buffer_load_dwordx4 v[160:163], v2, s[20:23], s96 offen sc1
    buffer_load_dwordx4 v[164:167], v2, s[20:23], s97 offen sc1
    s_waitcnt vmcnt(0)
    v_perm_b32 v235, v171, v168, s36
    v_and_b32 v235, 0x101, v235
    v_and_b32 v168, -2, v168
    v_cmp_ne_u32 vcc, s37, v235
    v_and_b32 v171, -2, v171
    s_nop 1
    s_cbranch_vccnz L_rtL12
    s_branch L_bkL12
L_rtL13:
    s_add_u32 s47, s47, 1
    s_cmp_ge_u32 s47, 4096
    s_cbranch_scc1 L_bkL13
    buffer_load_dwordx4 v[172:175], v12, s[20:23], s1 offen sc1
    buffer_load_dwordx4 v[176:179], v2, s[20:23], s48 offen sc1
    buffer_load_dwordx4 v[180:183], v2, s[20:23], s49 offen sc1
    buffer_load_dwordx4 v[184:187], v2, s[20:23], s50 offen sc1
    buffer_load_dwordx4 v[188:191], v2, s[20:23], s51 offen sc1
    buffer_load_dwordx4 v[192:195], v2, s[20:23], s52 offen sc1
    buffer_load_dwordx4 v[196:199], v2, s[20:23], s53 offen sc1
    buffer_load_dwordx4 v[160:163], v2, s[20:23], s96 offen sc1
    buffer_load_dwordx4 v[164:167], v2, s[20:23], s97 offen sc1
    buffer_load_dwordx4 v[168:171], v2, s[20:23], s40 offen sc1
    s_waitcnt vmcnt(0)
    v_perm_b32 v235, v175, v172, s36
    v_and_b32 v235, 0x101, v235
    v_and_b32 v172, -2, v172
    v_cmp_ne_u32 vcc, s37, v235
    v_and_b32 v175, -2, v175
    s_nop 1
    s_cbranch_vccnz L_rtL13
    s_branch L_bkL13
L_rtL14:
    s_add_u32 s47, s47, 1
    s_cmp_ge_u32 s47, 4096
    s_cbranch_scc1 L_bkL14
    buffer_load_dwordx4 v[176:179], v2, s[20:23], s48 offen sc1
    buffer_load_dwordx4 v[180:183], v2, s[20:23], s49 offen sc1
    buffer_load_dwordx4 v[184:187], v2, s[20:23], s50 offen sc1
    buffer_load_dwordx4 v[188:191], v2, s[20:23], s51 offen sc1
    buffer_load_dwordx4 v[192:195], v2, s[20:23], s52 offen sc1
    buffer_load_dwordx4 v[196:199], v2, s[20:23], s53 offen sc1
    buffer_load_dwordx4 v[160:163], v2, s[20:23], s96 offen sc1
    buffer_load_dwordx4 v[164:167], v2, s[20:23], s97 offen sc1
    buffer_load_dwordx4 v[168:171], v2, s[20:23], s40 offen sc1
    buffer_load_dwordx4 v[172:175], v2, s[20:23], s41 offen sc1
    s_waitcnt vmcnt(0)
    v_perm_b32 v235, v179, v176, s36
    v_and_b32 v235, 0x101, v235
    v_and_b32 v176, -2, v176
    v_cmp_ne_u32 vcc, s37, v235
    v_and_b32 v179, -2, v179
    s_nop 1
    s_cbranch_vccnz L_rtL14
    s_branch L_bkL14
L_rtL15:
    s_add_u32 s47, s47, 1
    s_cmp_ge_u32 s47, 4096
    s_cbranch_scc1 L_bkL15
    buffer_load_dwordx4 v[180:183], v2, s[20:23], s49 offen sc1
    buffer_load_dwordx4 v[184:187], v2, s[20:23], s50 offen sc1
    buffer_load_dwordx4 v[188:191], v2, s[20:23], s51 offen sc1
    buffer_load_dwordx4 v[192:195], v2, s[20:23], s52 offen sc1
    buffer_load_dwordx4 v[196:199], v2, s[20:23], s53 offen sc1
    buffer_load_dwordx4 v[160:163], v2, s[20:23], s96 offen sc1
    buffer_load_dwordx4 v[164:167], v2, s[20:23], s97 offen sc1
    buffer_load_dwordx4 v[168:171], v2, s[20:23], s40 offen sc1
    buffer_load_dwordx4 v[172:175], v2, s[20:23], s41 offen sc1
    buffer_load_dwordx4 v[176:179], v2, s[20:23], s43 offen sc1
    s_waitcnt vmcnt(0)
    v_perm_b32 v235, v183, v180, s36
    v_and_b32 v235, 0x101, v235
    v_and_b32 v180, -2, v180
    v_cmp_ne_u32 vcc, s37, v235
    v_and_b32 v183, -2, v183
    s_nop 1
    s_cbranch_vccnz L_rtL15
    s_branch L_bkL15
L_rtL16:
    s_add_u32 s47, s47, 1
    s_cmp_ge_u32 s47, 4096
    s_cbranch_scc1 L_bkL16
    buffer_load_dwordx4 v[184:187], v2, s[20:23], s50 offen sc1
    buffer_load_dwordx4 v[188:191], v2, s[20:23], s51 offen sc1
    buffer_load_dwordx4 v[192:195], v2, s[20:23], s52 offen sc1
    buffer_load_dwordx4 v[196:199], v2, s[20:23], s53 offen sc1
    buffer_load_dwordx4 v[160:163], v2, s[20:23], s96 offen sc1
    buffer_load_dwordx4 v[164:167], v2, s[20:23], s97 offen sc1
    buffer_load_dwordx4 v[168:171], v2, s[20:23], s40 offen sc1
    buffer_load_dwordx4 v[172:175], v2, s[20:23], s41 offen sc1
    buffer_load_dwordx4 v[176:179], v2, s[20:23], s43 offen sc1
    buffer_load_dwordx4 v[180:183], v2, s[20:23], s44 offen sc1
    s_waitcnt vmcnt(0)
    v_perm_b32 v235, v187, v184, s36
    v_and_b32 v235, 0x101, v235
    v_and_b32 v184, -2, v184
    v_cmp_ne_u32 vcc, s37, v235
    v_and_b32 v187, -2, v187
    s_nop 1
    s_cbranch_vccnz L_rtL16
    s_branch L_bkL16
L_rtL17:
    s_add_u32 s47, s47, 1
    s_cmp_ge_u32 s47, 4096
    s_cbranch_scc1 L_bkL17
    buffer_load_dwordx4 v[188:191], v2, s[20:23], s51 offen sc1
    buffer_load_dwordx4 v[192:195], v2, s[20:23], s52 offen sc1
    buffer_load_dwordx4 v[196:199], v2, s[20:23], s53 offen sc1
    buffer_load_dwordx4 v[160:163], v2, s[20:23], s96 offen sc1
    buffer_load_dwordx4 v[164:167], v2, s[20:23], s97 offen sc1
    buffer_load_dwordx4 v[168:171], v2, s[20:23], s40 offen sc1
    buffer_load_dwordx4 v[172:175], v2, s[20:23], s41 offen sc1
    buffer_load_dwordx4 v[176:179], v2, s[20:23], s43 offen sc1
    buffer_load_dwordx4 v[180:183], v2, s[20:23], s44 offen sc1
    buffer_load_dwordx4 v[184:187], v2, s[20:23], s0 offen sc1
    s_waitcnt vmcnt(0)
    v_perm_b32 v235, v191, v188, s36
    v_and_b32 v235, 0x101, v235
    v_and_b32 v188, -2, v188
    v_cmp_ne_u32 vcc, s37, v235
    v_and_b32 v191, -2, v191
    s_nop 1
    s_cbranch_vccnz L_rtL17
    s_branch L_bkL17
L_rtL18:
    s_add_u32 s47, s47, 1
    s_cmp_ge_u32 s47, 4096
    s_cbranch_scc1 L_bkL18
    buffer_load_dwordx4 v[192:195], v2, s[20:23], s52 offen sc1
    buffer_load_dwordx4 v[196:199], v2, s[20:23], s53 offen sc1
    buffer_load_dwordx4 v[160:163], v2, s[20:23], s96 offen sc1
    buffer_load_dwordx4 v[164:167], v2, s[20:23], s97 offen sc1
    buffer_load_dwordx4 v[168:171], v2, s[20:23], s40 offen sc1
    buffer_load_dwordx4 v[172:175], v2, s[20:23], s41 offen sc1
    buffer_load_dwordx4 v[176:179], v2, s[20:23], s43 offen sc1
    buffer_load_dwordx4 v[180:183], v2, s[20:23], s44 offen sc1
    buffer_load_dwordx4 v[184:187], v2, s[20:23], s0 offen sc1
    buffer_load_dwordx4 v[188:191], v2, s[20:23], s1 offen sc1
    s_waitcnt vmcnt(0)
    v_perm_b32 v235, v195, v192, s36
    v_and_b32 v235, 0x101, v235
    v_and_b32 v192, -2, v192
    v_cmp_ne_u32 vcc, s37, v235
    v_and_b32 v195, -2, v195
    s_nop 1
    s_cbranch_vccnz L_rtL18
    s_branch L_bkL18
L_rtL19:
    s_add_u32 s47, s47, 1
    s_cmp_ge_u32 s47, 4096
    s_cbranch_scc1 L_bkL19
    buffer_load_dwordx4 v[196:199], v2, s[20:23], s53 offen sc1
    buffer_load_dwordx4 v[160:163], v2, s[20:23], s96 offen sc1
    buffer_load_dwordx4 v[164:167], v2, s[20:23], s97 offen sc1
    buffer_load_dwordx4 v[168:171], v2, s[20:23], s40 offen sc1
    buffer_load_dwordx4 v[172:175], v2, s[20:23], s41 offen sc1
    buffer_load_dwordx4 v[176:179], v2, s[20:23], s43 offen sc1
    buffer_load_dwordx4 v[180:183], v2, s[20:23], s44 offen sc1
    buffer_load_dwordx4 v[184:187], v2, s[20:23], s0 offen sc1
    buffer_load_dwordx4 v[188:191], v2, s[20:23], s1 offen sc1
    s_waitcnt vmcnt(0)
    v_perm_b32 v235, v199, v196, s36
    v_and_b32 v235, 0x101, v235
    v_and_b32 v196, -2, v196
    v_cmp_ne_u32 vcc, s37, v235
    v_and_b32 v199, -2, v199
    s_nop 1
    s_cbranch_vccnz L_rtL19
    s_branch L_bkL19
L_rtL20:
    s_add_u32 s47, s47, 1
    s_cmp_ge_u32 s47, 4096
    s_cbranch_scc1 L_bkL20
    buffer_load_dwordx4 v[160:163], v2, s[20:23], s96 offen sc1
    buffer_load_dwordx4 v[164:167], v2, s[20:23], s97 offen sc1
    buffer_load_dwordx4 v[168:171], v2, s[20:23], s40 offen sc1
    buffer_load_dwordx4 v[172:175], v2, s[20:23], s41 offen sc1
    buffer_load_dwordx4 v[176:179], v2, s[20:23], s43 offen sc1
    buffer_load_dwordx4 v[180:183], v2, s[20:23], s44 offen sc1
    buffer_load_dwordx4 v[184:187], v2, s[20:23], s0 offen sc1
    buffer_load_dwordx4 v[188:191], v2, s[20:23], s1 offen sc1
    s_waitcnt vmcnt(0)
    v_perm_b32 v235, v163, v160, s36
    v_and_b32 v235, 0x101, v235
    v_and_b32 v160, -2, v160
    v_cmp_ne_u32 vcc, s37, v235
    v_and_b32 v163, -2, v163
    s_nop 1
    s_cbranch_vccnz L_rtL20
    s_branch L_bkL20
L_rtL21:
    s_add_u32 s47, s47, 1
    s_cmp_ge_u32 s47, 4096
    s_cbranch_scc1 L_bkL21
    buffer_load_dwordx4 v[164:167], v2, s[20:23], s97 offen sc1
    buffer_load_dwordx4 v[168:171], v2, s[20:23], s40 offen sc1
    buffer_load_dwordx4 v[172:175], v2, s[20:23], s41 offen sc1
    buffer_load_dwordx4 v[176:179], v2, s[20:23], s43 offen sc1
    buffer_load_dwordx4 v[180:183], v2, s[20:23], s44 offen sc1
    buffer_load_dwordx4 v[184:187], v2, s[20:23], s0 offen sc1
    buffer_load_dwordx4 v[188:191], v2, s[20:23], s1 offen sc1
    s_waitcnt vmcnt(0)
    v_perm_b32 v235, v167, v164, s36
    v_and_b32 v235, 0x101, v235
    v_and_b32 v164, -2, v164
    v_cmp_ne_u32 vcc, s37, v235
    v_and_b32 v167, -2, v167
    s_nop 1
    s_cbranch_vccnz L_rtL21
    s_branch L_bkL21
L_rtL22:
    s_add_u32 s47, s47, 1
    s_cmp_ge_u32 s47, 4096
    s_cbranch_scc1 L_bkL22
    buffer_load_dwordx4 v[168:171], v2, s[20:23], s40 offen sc1
    buffer_load_dwordx4 v[172:175], v2, s[20:23], s41 offen sc1
    buffer_load_dwordx4 v[176:179], v2, s[20:23], s43 offen sc1
    buffer_load_dwordx4 v[180:183], v2, s[20:23], s44 offen sc1
    buffer_load_dwordx4 v[184:187], v2, s[20:23], s0 offen sc1
    buffer_load_dwordx4 v[188:191], v2, s[20:23], s1 offen sc1
    s_waitcnt vmcnt(0)
    v_perm_b32 v235, v171, v168, s36
    v_and_b32 v235, 0x101, v235
    v_and_b32 v168, -2, v168
    v_cmp_ne_u32 vcc, s37, v235
    v_and_b32 v171, -2, v171
    s_nop 1
    s_cbranch_vccnz L_rtL22
    s_branch L_bkL22
L_rtL23:
    s_add_u32 s47, s47, 1
    s_cmp_ge_u32 s47, 4096
    s_cbranch_scc1 L_bkL23
    buffer_load_dwordx4 v[172:175], v2, s[20:23], s41 offen sc1
    buffer_load_dwordx4 v[176:179], v2, s[20:23], s43 offen sc1
    buffer_load_dwordx4 v[180:183], v2, s[20:23], s44 offen sc1
    buffer_load_dwordx4 v[184:187], v2, s[20:23], s0 offen sc1
    buffer_load_dwordx4 v[188:191], v2, s[20:23], s1 offen sc1
    s_waitcnt vmcnt(0)
    v_perm_b32 v235, v175, v172, s36
    v_and_b32 v235, 0x101, v235
    v_and_b32 v172, -2, v172
    v_cmp_ne_u32 vcc, s37, v235
    v_and_b32 v175, -2, v175
    s_nop 1
    s_cbranch_vccnz L_rtL23
    s_branch L_bkL23
L_rtL24:
    s_add_u32 s47, s47, 1
    s_cmp_ge_u32 s47, 4096
    s_cbranch_scc1 L_bkL24
    buffer_load_dwordx4 v[176:179], v2, s[20:23], s43 offen sc1
    buffer_load_dwordx4 v[180:183], v2, s[20:23], s44 offen sc1
    buffer_load_dwordx4 v[184:187], v2, s[20:23], s0 offen sc1
    buffer_load_dwordx4 v[188:191], v2, s[20:23], s1 offen sc1
    s_waitcnt vmcnt(0)
    v_perm_b32 v235, v179, v176, s36
    v_and_b32 v235, 0x101, v235
    v_and_b32 v176, -2, v176
    v_cmp_ne_u32 vcc, s37, v235
    v_and_b32 v179, -2, v179
    s_nop 1
    s_cbranch_vccnz L_rtL24
    s_branch L_bkL24
L_rtL25:
    s_add_u32 s47, s47, 1
    s_cmp_ge_u32 s47, 4096
    s_cbranch_scc1 L_bkL25
    buffer_load_dwordx4 v[180:183], v2, s[20:23], s44 offen sc1
    buffer_load_dwordx4 v[184:187], v2, s[20:23], s0 offen sc1
    buffer_load_dwordx4 v[188:191], v2, s[20:23], s1 offen sc1
    s_waitcnt vmcnt(0)
    v_perm_b32 v235, v183, v180, s36
    v_and_b32 v235, 0x101, v235
    v_and_b32 v180, -2, v180
    v_cmp_ne_u32 vcc, s37, v235
    v_and_b32 v183, -2, v183
    s_nop 1
    s_cbranch_vccnz L_rtL25
    s_branch L_bkL25
L_rtL26:
    s_add_u32 s47, s47, 1
    s_cmp_ge_u32 s47, 4096
    s_cbranch_scc1 L_bkL26
    buffer_load_dwordx4 v[184:187], v2, s[20:23], s0 offen sc1
    buffer_load_dwordx4 v[188:191], v2, s[20:23], s1 offen sc1
    s_waitcnt vmcnt(0)
    v_perm_b32 v235, v187, v184, s36
    v_and_b32 v235, 0x101, v235
    v_and_b32 v184, -2, v184
    v_cmp_ne_u32 vcc, s37, v235
    v_and_b32 v187, -2, v187
    s_nop 1
    s_cbranch_vccnz L_rtL26
    s_branch L_bkL26
L_rtL27:
    s_add_u32 s47, s47, 1
    s_cmp_ge_u32 s47, 4096
    s_cbranch_scc1 L_bkL27
    buffer_load_dwordx4 v[188:191], v2, s[20:23], s1 offen sc1
    s_waitcnt vmcnt(0)
    v_perm_b32 v235, v191, v188, s36
    v_and_b32 v235, 0x101, v235
    v_and_b32 v188, -2, v188
    v_cmp_ne_u32 vcc, s37, v235
    v_and_b32 v191, -2, v191
    s_nop 1
    s_cbranch_vccnz L_rtL27
    s_branch L_bkL27
L_rtH0:
    s_add_u32 s47, s47, 1
    s_cmp_ge_u32 s47, 4096
    s_cbranch_scc1 L_bkH0
    buffer_load_dwordx4 v[160:163], v12, s[20:23], s48 offen sc1
    buffer_load_dwordx4 v[164:167], v12, s[20:23], s49 offen sc1
    buffer_load_dwordx4 v[168:171], v12, s[20:23], s50 offen sc1
    buffer_load_dwordx4 v[172:175], v12, s[20:23], s51 offen sc1
    buffer_load_dwordx4 v[176:179], v12, s[20:23], s52 offen sc1
    buffer_load_dwordx4 v[180:183], v12, s[20:23], s53 offen sc1
    buffer_load_dwordx4 v[184:187], v12, s[20:23], s96 offen sc1
    buffer_load_dwordx4 v[188:191], v12, s[20:23], s97 offen sc1
    buffer_load_dwordx4 v[192:195], v12, s[20:23], s40 offen sc1
    buffer_load_dwordx4 v[196:199], v12, s[20:23], s41 offen sc1
    s_waitcnt vmcnt(0)
    v_perm_b32 v235, v163, v160, s36
    v_and_b32 v235, 0x101, v235
    v_and_b32 v160, -2, v160
    v_cmp_ne_u32 vcc, s37, v235
    v_and_b32 v163, -2, v163
    s_nop 1
    s_cbranch_vccnz L_rtH0
    s_branch L_bkH0
L_rtH1:
    s_add_u32 s47, s47, 1
    s_cmp_ge_u32 s47, 4096
    s_cbranch_scc1 L_bkH1
    buffer_load_dwordx4 v[164:167], v12, s[20:23], s49 offen sc1
    buffer_load_dwordx4 v[168:171], v12, s[20:23], s50 offen sc1
    buffer_load_dwordx4 v[172:175], v12, s[20:23], s51 offen sc1
    buffer_load_dwordx4 v[176:179], v12, s[20:23], s52 offen sc1
    buffer_load_dwordx4 v[180:183], v12, s[20:23], s53 offen sc1
    buffer_load_dwordx4 v[184:187], v12, s[20:23], s96 offen sc1
    buffer_load_dwordx4 v[188:191], v12, s[20:23], s97 offen sc1
    buffer_load_dwordx4 v[192:195], v12, s[20:23], s40 offen sc1
    buffer_load_dwordx4 v[196:199], v12, s[20:23], s41 offen sc1
    buffer_load_dwordx4 v[160:163], v12, s[20:23], s43 offen sc1
    s_waitcnt vmcnt(0)
    v_perm_b32 v235, v167, v164, s36
    v_and_b32 v235, 0x101, v235
    v_and_b32 v164, -2, v164
    v_cmp_ne_u32 vcc, s37, v235
    v_and_b32 v167, -2, v167
    s_nop 1
    s_cbranch_vccnz L_rtH1
    s_branch L_bkH1
L_rtH2:
    s_add_u32 s47, s47, 1
    s_cmp_ge_u32 s47, 4096
    s_cbranch_scc1 L_bkH2
    buffer_load_dwordx4 v[168:171], v12, s[20:23], s50 offen sc1
    buffer_load_dwordx4 v[172:175], v12, s[20:23], s51 offen sc1
    buffer_load_dwordx4 v[176:179], v12, s[20:23], s52 offen sc1
    buffer_load_dwordx4 v[180:183], v12, s[20:23], s53 offen sc1
    buffer_load_dwordx4 v[184:187], v12, s[20:23], s96 offen sc1
    buffer_load_dwordx4 v[188:191], v12, s[20:23], s97 offen sc1
    buffer_load_dwordx4 v[192:195], v12, s[20:23], s40 offen sc1
    buffer_load_dwordx4 v[196:199], v12, s[20:23], s41 offen sc1
    buffer_load_dwordx4 v[160:163], v12, s[20:23], s43 offen sc1
    buffer_load_dwordx4 v[164:167], v12, s[20:23], s44 offen sc1
    s_waitcnt vmcnt(0)
    v_perm_b32 v235, v171, v168, s36
    v_and_b32 v235, 0x101, v235
    v_and_b32 v168, -2, v168
    v_cmp_ne_u32 vcc, s37, v235
    v_and_b32 v171, -2, v171
    s_nop 1
    s_cbranch_vccnz L_rtH2
    s_branch L_bkH2
L_rtH3:
    s_add_u32 s47, s47, 1
    s_cmp_ge_u32 s47, 4096
    s_cbranch_scc1 L_bkH3
    buffer_load_dwordx4 v[172:175], v12, s[20:23], s51 offen sc1
    buffer_load_dwordx4 v[176:179], v12, s[20:23], s52 offen sc1
    buffer_load_dwordx4 v[180:183], v12, s[20:23], s53 offen sc1
    buffer_load_dwordx4 v[184:187], v12, s[20:23], s96 offen sc1
    buffer_load_dwordx4 v[188:191], v12, s[20:23], s97 offen sc1
    buffer_load_dwordx4 v[192:195], v12, s[20:23], s40 offen sc1
    buffer_load_dwordx4 v[196:199], v12, s[20:23], s41 offen sc1
    buffer_load_dwordx4 v[160:163], v12, s[20:23], s43 offen sc1
    buffer_load_dwordx4 v[164:167], v12, s[20:23], s44 offen sc1
    buffer_load_dwordx4 v[168:171], v12, s[20:23], s0 offen sc1
    s_waitcnt vmcnt(0)
    v_perm_b32 v235, v175, v172, s36
    v_and_b32 v235, 0x101, v235
    v_and_b32 v172, -2, v172
    v_cmp_ne_u32 vcc, s37, v235
    v_and_b32 v175, -2, v175
    s_nop 1
    s_cbranch_vccnz L_rtH3
    s_branch L_bkH3
L_rtH4:
    s_add_u32 s47, s47, 1
    s_cmp_ge_u32 s47, 4096
    s_cbranch_scc1 L_bkH4
    buffer_load_dwordx4 v[176:179], v12, s[20:23], s52 offen sc1
    buffer_load_dwordx4 v[180:183], v12, s[20:23], s53 offen sc1
    buffer_load_dwordx4 v[184:187], v12, s[20:23], s96 offen sc1
    buffer_load_dwordx4 v[188:191], v12, s[20:23], s97 offen sc1
    buffer_load_dwordx4 v[192:195], v12, s[20:23], s40 offen sc1
    buffer_load_dwordx4 v[196:199], v12, s[20:23], s41 offen sc1
    buffer_load_dwordx4 v[160:163], v12, s[20:23], s43 offen sc1
    buffer_load_dwordx4 v[164:167], v12, s[20:23], s44 offen sc1
    buffer_load_dwordx4 v[168:171], v12, s[20:23], s0 offen sc1
    buffer_load_dwordx4 v[172:175], v12, s[20:23], s1 offen sc1
    s_waitcnt vmcnt(0)
    v_perm_b32 v235, v179, v176, s36
    v_and_b32 v235, 0x101, v235
    v_and_b32 v176, -2, v176
    v_cmp_ne_u32 vcc, s37, v235
    v_and_b32 v179, -2, v179
    s_nop 1
    s_cbranch_vccnz L_rtH4
    s_branch L_bkH4
L_rtH5:
    s_add_u32 s47, s47, 1
    s_cmp_ge_u32 s47, 4096
    s_cbranch_scc1 L_bkH5
    buffer_load_dwordx4 v[180:183], v12, s[20:23], s53 offen sc1
    buffer_load_dwordx4 v[184:187], v12, s[20:23], s96 offen sc1
    buffer_load_dwordx4 v[188:191], v12, s[20:23], s97 offen sc1
    buffer_load_dwordx4 v[192:195], v12, s[20:23], s40 offen sc1
    buffer_load_dwordx4 v[196:199], v12, s[20:23], s41 offen sc1
    buffer_load_dwordx4 v[160:163], v12, s[20:23], s43 offen sc1
    buffer_load_dwordx4 v[164:167], v12, s[20:23], s44 offen sc1
    buffer_load_dwordx4 v[168:171], v12, s[20:23], s0 offen sc1
    buffer_load_dwordx4 v[172:175], v12, s[20:23], s1 offen sc1
    buffer_load_dwordx4 v[176:179], v2, s[20:23], s48 offen sc1
    s_waitcnt vmcnt(0)
    v_perm_b32 v235, v183, v180, s36
    v_and_b32 v235, 0x101, v235
    v_and_b32 v180, -2, v180
    v_cmp_ne_u32 vcc, s37, v235
    v_and_b32 v183, -2, v183
    s_nop 1
    s_cbranch_vccnz L_rtH5
    s_branch L_bkH5
L_rtH6:
    s_add_u32 s47, s47, 1
    s_cmp_ge_u32 s47, 4096
    s_cbranch_scc1 L_bkH6
    buffer_load_dwordx4 v[184:187], v12, s[20:23], s96 offen sc1
    buffer_load_dwordx4 v[188:191], v12, s[20:23], s97 offen sc1
    buffer_load_dwordx4 v[192:195], v12, s[20:23], s40 offen sc1
    buffer_load_dwordx4 v[196:199], v12, s[20:23], s41 offen sc1
    buffer_load_dwordx4 v[160:163], v12, s[20:23], s43 offen sc1
    buffer_load_dwordx4 v[164:167], v12, s[20:23], s44 offen sc1
    buffer_load_dwordx4 v[168:171], v12, s[20:23], s0 offen sc1
    buffer_load_dwordx4 v[172:175], v12, s[20:23], s1 offen sc1
    buffer_load_dwordx4 v[176:179], v2, s[20:23], s48 offen sc1
    buffer_load_dwordx4 v[180:183], v2, s[20:23], s49 offen sc1
    s_waitcnt vmcnt(0)
    v_perm_b32 v235, v187, v184, s36
    v_and_b32 v235, 0x101, v235
    v_and_b32 v184, -2, v184
    v_cmp_ne_u32 vcc, s37, v235
    v_and_b32 v187, -2, v187
    s_nop 1
    s_cbranch_vccnz L_rtH6
    s_branch L_bkH6
L_rtH7:
    s_add_u32 s47, s47, 1
    s_cmp_ge_u32 s47, 4096
    s_cbranch_scc1 L_bkH7
    buffer_load_dwordx4 v[188:191], v12, s[20:23], s97 offen sc1
    buffer_load_dwordx4 v[192:195], v12, s[20:23], s40 offen sc1
    buffer_load_dwordx4 v[196:199], v12, s[20:23], s41 offen sc1
    buffer_load_dwordx4 v[160:163], v12, s[20:23], s43 offen sc1
    buffer_load_dwordx4 v[164:167], v12, s[20:23], s44 offen sc1
    buffer_load_dwordx4 v[168:171], v12, s[20:23], s0 offen sc1
    buffer_load_dwordx4 v[172:175], v12, s[20:23], s1 offen sc1
    buffer_load_dwordx4 v[176:179], v2, s[20:23], s48 offen sc1
    buffer_load_dwordx4 v[180:183], v2, s[20:23], s49 offen sc1
    buffer_load_dwordx4 v[184:187], v2, s[20:23], s50 offen sc1
    s_waitcnt vmcnt(0)
    v_perm_b32 v235, v191, v188, s36
    v_and_b32 v235, 0x101, v235
    v_and_b32 v188, -2, v188
    v_cmp_ne_u32 vcc, s37, v235
    v_and_b32 v191, -2, v191
    s_nop 1
    s_cbranch_vccnz L_rtH7
    s_branch L_bkH7
L_rtH8:
    s_add_u32 s47, s47, 1
    s_cmp_ge_u32 s47, 4096
    s_cbranch_scc1 L_bkH8
    buffer_load_dwordx4 v[192:195], v12, s[20:23], s40 offen sc1
    buffer_load_dwordx4 v[196:199], v12, s[20:23], s41 offen sc1
    buffer_load_dwordx4 v[160:163], v12, s[20:23], s43 offen sc1
    buffer_load_dwordx4 v[164:167], v12, s[20:23], s44 offen sc1
    buffer_load_dwordx4 v[168:171], v12, s[20:23], s0 offen sc1
    buffer_load_dwordx4 v[172:175], v12, s[20:23], s1 offen sc1
    buffer_load_dwordx4 v[176:179], v2, s[20:23], s48 offen sc1
    buffer_load_dwordx4 v[180:183], v2, s[20:23], s49 offen sc1
    buffer_load_dwordx4 v[184:187], v2, s[20:23], s50 offen sc1
    buffer_load_dwordx4 v[188:191], v2, s[20:23], s51 offen sc1
    s_waitcnt vmcnt(0)
    v_perm_b32 v235, v195, v192, s36
    v_and_b32 v235, 0x101, v235
    v_and_b32 v192, -2, v192
    v_cmp_ne_u32 vcc, s37, v235
    v_and_b32 v195, -2, v195
    s_nop 1
    s_cbranch_vccnz L_rtH8
    s_branch L_bkH8
L_rtH9:
    s_add_u32 s47, s47, 1
    s_cmp_ge_u32 s47, 4096
    s_cbranch_scc1 L_bkH9
    buffer_load_dwordx4 v[196:199], v12, s[20:23], s41 offen sc1
    buffer_load_dwordx4 v[160:163], v12, s[20:23], s43 offen sc1
    buffer_load_dwordx4 v[164:167], v12, s[20:23], s44 offen sc1
    buffer_load_dwordx4 v[168:171], v12, s[20:23], s0 offen sc1
    buffer_load_dwordx4 v[172:175], v12, s[20:23], s1 offen sc1
    buffer_load_dwordx4 v[176:179], v2, s[20:23], s48 offen sc1
    buffer_load_dwordx4 v[180:183], v2, s[20:23], s49 offen sc1
    buffer_load_dwordx4 v[184:187], v2, s[20:23], s50 offen sc1
    buffer_load_dwordx4 v[188:191], v2, s[20:23], s51 offen sc1
    buffer_load_dwordx4 v[192:195], v2, s[20:23], s52 offen sc1
    s_waitcnt vmcnt(0)
    v_perm_b32 v235, v199, v196, s36
    v_and_b32 v235, 0x101, v235
    v_and_b32 v196, -2, v196
    v_cmp_ne_u32 vcc, s37, v235
    v_and_b32 v199, -2, v199
    s_nop 1
    s_cbranch_vccnz L_rtH9
    s_branch L_bkH9
L_rtH10:
    s_add_u32 s47, s47, 1
    s_cmp_ge_u32 s47, 4096
    s_cbranch_scc1 L_bkH10
    buffer_load_dwordx4 v[160:163], v12, s[20:23], s43 offen sc1
    buffer_load_dwordx4 v[164:167], v12, s[20:23], s44 offen sc1
    buffer_load_dwordx4 v[168:171], v12, s[20:23], s0 offen sc1
    buffer_load_dwordx4 v[172:175], v12, s[20:23], s1 offen sc1
    buffer_load_dwordx4 v[176:179], v2, s[20:23], s48 offen sc1
    buffer_load_dwordx4 v[180:183], v2, s[20:23], s49 offen sc1
    buffer_load_dwordx4 v[184:187], v2, s[20:23], s50 offen sc1
    buffer_load_dwordx4 v[188:191], v2, s[20:23], s51 offen sc1
    buffer_load_dwordx4 v[192:195], v2, s[20:23], s52 offen sc1
    buffer_load_dwordx4 v[196:199], v2, s[20:23], s53 offen sc1
    s_waitcnt vmcnt(0)
    v_perm_b32 v235, v163, v160, s36
    v_and_b32 v235, 0x101, v235
    v_and_b32 v160, -2, v160
    v_cmp_ne_u32 vcc, s37, v235
    v_and_b32 v163, -2, v163
    s_nop 1
    s_cbranch_vccnz L_rtH10
    s_branch L_bkH10
L_rtH11:
    s_add_u32 s47, s47, 1
    s_cmp_ge_u32 s47, 4096
    s_cbranch_scc1 L_bkH11
    buffer_load_dwordx4 v[164:167], v12, s[20:23], s44 offen sc1
    buffer_load_dwordx4 v[168:171], v12, s[20:23], s0 offen sc1
    buffer_load_dwordx4 v[172:175], v12, s[20:23], s1 offen sc1
    buffer_load_dwordx4 v[176:179], v2, s[20:23], s48 offen sc1
    buffer_load_dwordx4 v[180:183], v2, s[20:23], s49 offen sc1
    buffer_load_dwordx4 v[184:187], v2, s[20:23], s50 offen sc1
    buffer_load_dwordx4 v[188:191], v2, s[20:23], s51 offen sc1
    buffer_load_dwordx4 v[192:195], v2, s[20:23], s52 offen sc1
    buffer_load_dwordx4 v[196:199], v2, s[20:23], s53 offen sc1
    buffer_load_dwordx4 v[160:163], v2, s[20:23], s96 offen sc1
    s_waitcnt vmcnt(0)
    v_perm_b32 v235, v167, v164, s36
    v_and_b32 v235, 0x101, v235
    v_and_b32 v164, -2, v164
    v_cmp_ne_u32 vcc, s37, v235
    v_and_b32 v167, -2, v167
    s_nop 1
    s_cbranch_vccnz L_rtH11
    s_branch L_bkH11
L_rtH12:
    s_add_u32 s47, s47, 1
    s_cmp_ge_u32 s47, 4096
    s_cbranch_scc1 L_bkH12
    buffer_load_dwordx4 v[168:171], v12, s[20:23], s0 offen sc1
    buffer_load_dwordx4 v[172:175], v12, s[20:23], s1 offen sc1
    buffer_load_dwordx4 v[176:179], v2, s[20:23], s48 offen sc1
    buffer_load_dwordx4 v[180:183], v2, s[20:23], s49 offen sc1
    buffer_load_dwordx4 v[184:187], v2, s[20:23], s50 offen sc1
    buffer_load_dwordx4 v[188:191], v2, s[20:23], s51 offen sc1
    buffer_load_dwordx4 v[192:195], v2, s[20:23], s52 offen sc1
    buffer_load_dwordx4 v[196:199], v2, s[20:23], s53 offen sc1
    buffer_load_dwordx4 v[160:163], v2, s[20:23], s96 offen sc1
    buffer_load_dwordx4 v[164:167], v2, s[20:23], s97 offen sc1
    s_waitcnt vmcnt(0)
    v_perm_b32 v235, v171, v168, s36
    v_and_b32 v235, 0x101, v235
    v_and_b32 v168, -2, v168
    v_cmp_ne_u32 vcc, s37, v235
    v_and_b32 v171, -2, v171
    s_nop 1
    s_cbranch_vccnz L_rtH12
    s_branch L_bkH12
L_rtH13:
    s_add_u32 s47, s47, 1
    s_cmp_ge_u32 s47, 4096
    s_cbranch_scc1 L_bkH13
    buffer_load_dwordx4 v[172:175], v12, s[20:23], s1 offen sc1
    buffer_load_dwordx4 v[176:179], v2, s[20:23], s48 offen sc1
    buffer_load_dwordx4 v[180:183], v2, s[20:23], s49 offen sc1
    buffer_load_dwordx4 v[184:187], v2, s[20:23], s50 offen sc1
    buffer_load_dwordx4 v[188:191], v2, s[20:23], s51 offen sc1
    buffer_load_dwordx4 v[192:195], v2, s[20:23], s52 offen sc1
    buffer_load_dwordx4 v[196:199], v2, s[20:23], s53 offen sc1
    buffer_load_dwordx4 v[160:163], v2, s[20:23], s96 offen sc1
    buffer_load_dwordx4 v[164:167], v2, s[20:23], s97 offen sc1
    buffer_load_dwordx4 v[168:171], v2, s[20:23], s40 offen sc1
    s_waitcnt vmcnt(0)
    v_perm_b32 v235, v175, v172, s36
    v_and_b32 v235, 0x101, v235
    v_and_b32 v172, -2, v172
    v_cmp_ne_u32 vcc, s37, v235
    v_and_b32 v175, -2, v175
    s_nop 1
    s_cbranch_vccnz L_rtH13
    s_branch L_bkH13
L_rtH14:
    s_add_u32 s47, s47, 1
    s_cmp_ge_u32 s47, 4096
    s_cbranch_scc1 L_bkH14
    buffer_load_dwordx4 v[176:179], v2, s[20:23], s48 offen sc1
    buffer_load_dwordx4 v[180:183], v2, s[20:23], s49 offen sc1
    buffer_load_dwordx4 v[184:187], v2, s[20:23], s50 offen sc1
    buffer_load_dwordx4 v[188:191], v2, s[20:23], s51 offen sc1
    buffer_load_dwordx4 v[192:195], v2, s[20:23], s52 offen sc1
    buffer_load_dwordx4 v[196:199], v2, s[20:23], s53 offen sc1
    buffer_load_dwordx4 v[160:163], v2, s[20:23], s96 offen sc1
    buffer_load_dwordx4 v[164:167], v2, s[20:23], s97 offen sc1
    buffer_load_dwordx4 v[168:171], v2, s[20:23], s40 offen sc1
    buffer_load_dwordx4 v[172:175], v2, s[20:23], s41 offen sc1
    s_waitcnt vmcnt(0)
    v_perm_b32 v235, v179, v176, s36
    v_and_b32 v235, 0x101, v235
    v_and_b32 v176, -2, v176
    v_cmp_ne_u32 vcc, s37, v235
    v_and_b32 v179, -2, v179
    s_nop 1
    s_cbranch_vccnz L_rtH14
    s_branch L_bkH14
L_rtH15:
    s_add_u32 s47, s47, 1
    s_cmp_ge_u32 s47, 4096
    s_cbranch_scc1 L_bkH15
    buffer_load_dwordx4 v[180:183], v2, s[20:23], s49 offen sc1
    buffer_load_dwordx4 v[184:187], v2, s[20:23], s50 offen sc1
    buffer_load_dwordx4 v[188:191], v2, s[20:23], s51 offen sc1
    buffer_load_dwordx4 v[192:195], v2, s[20:23], s52 offen sc1
    buffer_load_dwordx4 v[196:199], v2, s[20:23], s53 offen sc1
    buffer_load_dwordx4 v[160:163], v2, s[20:23], s96 offen sc1
    buffer_load_dwordx4 v[164:167], v2, s[20:23], s97 offen sc1
    buffer_load_dwordx4 v[168:171], v2, s[20:23], s40 offen sc1
    buffer_load_dwordx4 v[172:175], v2, s[20:23], s41 offen sc1
    buffer_load_dwordx4 v[176:179], v2, s[20:23], s43 offen sc1
    s_waitcnt vmcnt(0)
    v_perm_b32 v235, v183, v180, s36
    v_and_b32 v235, 0x101, v235
    v_and_b32 v180, -2, v180
    v_cmp_ne_u32 vcc, s37, v235
    v_and_b32 v183, -2, v183
    s_nop 1
    s_cbranch_vccnz L_rtH15
    s_branch L_bkH15
L_rtH16:
    s_add_u32 s47, s47, 1
    s_cmp_ge_u32 s47, 4096
    s_cbranch_scc1 L_bkH16
    buffer_load_dwordx4 v[184:187], v2, s[20:23], s50 offen sc1
    buffer_load_dwordx4 v[188:191], v2, s[20:23], s51 offen sc1
    buffer_load_dwordx4 v[192:195], v2, s[20:23], s52 offen sc1
    buffer_load_dwordx4 v[196:199], v2, s[20:23], s53 offen sc1
    buffer_load_dwordx4 v[160:163], v2, s[20:23], s96 offen sc1
    buffer_load_dwordx4 v[164:167], v2, s[20:23], s97 offen sc1
    buffer_load_dwordx4 v[168:171], v2, s[20:23], s40 offen sc1
    buffer_load_dwordx4 v[172:175], v2, s[20:23], s41 offen sc1
    buffer_load_dwordx4 v[176:179], v2, s[20:23], s43 offen sc1
    buffer_load_dwordx4 v[180:183], v2, s[20:23], s44 offen sc1
    s_waitcnt vmcnt(0)
    v_perm_b32 v235, v187, v184, s36
    v_and_b32 v235, 0x101, v235
    v_and_b32 v184, -2, v184
    v_cmp_ne_u32 vcc, s37, v235
    v_and_b32 v187, -2, v187
    s_nop 1
    s_cbranch_vccnz L_rtH16
    s_branch L_bkH16
L_rtH17:
    s_add_u32 s47, s47, 1
    s_cmp_ge_u32 s47, 4096
    s_cbranch_scc1 L_bkH17
    buffer_load_dwordx4 v[188:191], v2, s[20:23], s51 offen sc1
    buffer_load_dwordx4 v[192:195], v2, s[20:23], s52 offen sc1
    buffer_load_dwordx4 v[196:199], v2, s[20:23], s53 offen sc1
    buffer_load_dwordx4 v[160:163], v2, s[20:23], s96 offen sc1
    buffer_load_dwordx4 v[164:167], v2, s[20:23], s97 offen sc1
    buffer_load_dwordx4 v[168:171], v2, s[20:23], s40 offen sc1
    buffer_load_dwordx4 v[172:175], v2, s[20:23], s41 offen sc1
    buffer_load_dwordx4 v[176:179], v2, s[20:23], s43 offen sc1
    buffer_load_dwordx4 v[180:183], v2, s[20:23], s44 offen sc1
    buffer_load_dwordx4 v[184:187], v2, s[20:23], s0 offen sc1
    s_waitcnt vmcnt(0)
    v_perm_b32 v235, v191, v188, s36
    v_and_b32 v235, 0x101, v235
    v_and_b32 v188, -2, v188
    v_cmp_ne_u32 vcc, s37, v235
    v_and_b32 v191, -2, v191
    s_nop 1
    s_cbranch_vccnz L_rtH17
    s_branch L_bkH17
L_rtH18:
    s_add_u32 s47, s47, 1
    s_cmp_ge_u32 s47, 4096
    s_cbranch_scc1 L_bkH18
    buffer_load_dwordx4 v[192:195], v2, s[20:23], s52 offen sc1
    buffer_load_dwordx4 v[196:199], v2, s[20:23], s53 offen sc1
    buffer_load_dwordx4 v[160:163], v2, s[20:23], s96 offen sc1
    buffer_load_dwordx4 v[164:167], v2, s[20:23], s97 offen sc1
    buffer_load_dwordx4 v[168:171], v2, s[20:23], s40 offen sc1
    buffer_load_dwordx4 v[172:175], v2, s[20:23], s41 offen sc1
    buffer_load_dwordx4 v[176:179], v2, s[20:23], s43 offen sc1
    buffer_load_dwordx4 v[180:183], v2, s[20:23], s44 offen sc1
    buffer_load_dwordx4 v[184:187], v2, s[20:23], s0 offen sc1
    buffer_load_dwordx4 v[188:191], v2, s[20:23], s1 offen sc1
    s_waitcnt vmcnt(0)
    v_perm_b32 v235, v195, v192, s36
    v_and_b32 v235, 0x101, v235
    v_and_b32 v192, -2, v192
    v_cmp_ne_u32 vcc, s37, v235
    v_and_b32 v195, -2, v195
    s_nop 1
    s_cbranch_vccnz L_rtH18
    s_branch L_bkH18
L_rtH19:
    s_add_u32 s47, s47, 1
    s_cmp_ge_u32 s47, 4096
    s_cbranch_scc1 L_bkH19
    buffer_load_dwordx4 v[196:199], v2, s[20:23], s53 offen sc1
    buffer_load_dwordx4 v[160:163], v2, s[20:23], s96 offen sc1
    buffer_load_dwordx4 v[164:167], v2, s[20:23], s97 offen sc1
    buffer_load_dwordx4 v[168:171], v2, s[20:23], s40 offen sc1
    buffer_load_dwordx4 v[172:175], v2, s[20:23], s41 offen sc1
    buffer_load_dwordx4 v[176:179], v2, s[20:23], s43 offen sc1
    buffer_load_dwordx4 v[180:183], v2, s[20:23], s44 offen sc1
    buffer_load_dwordx4 v[184:187], v2, s[20:23], s0 offen sc1
    buffer_load_dwordx4 v[188:191], v2, s[20:23], s1 offen sc1
    s_waitcnt vmcnt(0)
    v_perm_b32 v235, v199, v196, s36
    v_and_b32 v235, 0x101, v235
    v_and_b32 v196, -2, v196
    v_cmp_ne_u32 vcc, s37, v235
    v_and_b32 v199, -2, v199
    s_nop 1
    s_cbranch_vccnz L_rtH19
    s_branch L_bkH19
L_rtH20:
    s_add_u32 s47, s47, 1
    s_cmp_ge_u32 s47, 4096
    s_cbranch_scc1 L_bkH20
    buffer_load_dwordx4 v[160:163], v2, s[20:23], s96 offen sc1
    buffer_load_dwordx4 v[164:167], v2, s[20:23], s97 offen sc1
    buffer_load_dwordx4 v[168:171], v2, s[20:23], s40 offen sc1
    buffer_load_dwordx4 v[172:175], v2, s[20:23], s41 offen sc1
    buffer_load_dwordx4 v[176:179], v2, s[20:23], s43 offen sc1
    buffer_load_dwordx4 v[180:183], v2, s[20:23], s44 offen sc1
    buffer_load_dwordx4 v[184:187], v2, s[20:23], s0 offen sc1
    buffer_load_dwordx4 v[188:191], v2, s[20:23], s1 offen sc1
    s_waitcnt vmcnt(0)
    v_perm_b32 v235, v163, v160, s36
    v_and_b32 v235, 0x101, v235
    v_and_b32 v160, -2, v160
    v_cmp_ne_u32 vcc, s37, v235
    v_and_b32 v163, -2, v163
    s_nop 1
    s_cbranch_vccnz L_rtH20
    s_branch L_bkH20
L_rtH21:
    s_add_u32 s47, s47, 1
    s_cmp_ge_u32 s47, 4096
    s_cbranch_scc1 L_bkH21
    buffer_load_dwordx4 v[164:167], v2, s[20:23], s97 offen sc1
    buffer_load_dwordx4 v[168:171], v2, s[20:23], s40 offen sc1
    buffer_load_dwordx4 v[172:175], v2, s[20:23], s41 offen sc1
    buffer_load_dwordx4 v[176:179], v2, s[20:23], s43 offen sc1
    buffer_load_dwordx4 v[180:183], v2, s[20:23], s44 offen sc1
    buffer_load_dwordx4 v[184:187], v2, s[20:23], s0 offen sc1
    buffer_load_dwordx4 v[188:191], v2, s[20:23], s1 offen sc1
    s_waitcnt vmcnt(0)
    v_perm_b32 v235, v167, v164, s36
    v_and_b32 v235, 0x101, v235
    v_and_b32 v164, -2, v164
    v_cmp_ne_u32 vcc, s37, v235
    v_and_b32 v167, -2, v167
    s_nop 1
    s_cbranch_vccnz L_rtH21
    s_branch L_bkH21
L_rtH22:
    s_add_u32 s47, s47, 1
    s_cmp_ge_u32 s47, 4096
    s_cbranch_scc1 L_bkH22
    buffer_load_dwordx4 v[168:171], v2, s[20:23], s40 offen sc1
    buffer_load_dwordx4 v[172:175], v2, s[20:23], s41 offen sc1
    buffer_load_dwordx4 v[176:179], v2, s[20:23], s43 offen sc1
    buffer_load_dwordx4 v[180:183], v2, s[20:23], s44 offen sc1
    buffer_load_dwordx4 v[184:187], v2, s[20:23], s0 offen sc1
    buffer_load_dwordx4 v[188:191], v2, s[20:23], s1 offen sc1
    s_waitcnt vmcnt(0)
    v_perm_b32 v235, v171, v168, s36
    v_and_b32 v235, 0x101, v235
    v_and_b32 v168, -2, v168
    v_cmp_ne_u32 vcc, s37, v235
    v_and_b32 v171, -2, v171
    s_nop 1
    s_cbranch_vccnz L_rtH22
    s_branch L_bkH22
L_rtH23:
    s_add_u32 s47, s47, 1
    s_cmp_ge_u32 s47, 4096
    s_cbranch_scc1 L_bkH23
    buffer_load_dwordx4 v[172:175], v2, s[20:23], s41 offen sc1
    buffer_load_dwordx4 v[176:179], v2, s[20:23], s43 offen sc1
    buffer_load_dwordx4 v[180:183], v2, s[20:23], s44 offen sc1
    buffer_load_dwordx4 v[184:187], v2, s[20:23], s0 offen sc1
    buffer_load_dwordx4 v[188:191], v2, s[20:23], s1 offen sc1
    s_waitcnt vmcnt(0)
    v_perm_b32 v235, v175, v172, s36
    v_and_b32 v235, 0x101, v235
    v_and_b32 v172, -2, v172
    v_cmp_ne_u32 vcc, s37, v235
    v_and_b32 v175, -2, v175
    s_nop 1
    s_cbranch_vccnz L_rtH23
    s_branch L_bkH23
L_rtH24:
    s_add_u32 s47, s47, 1
    s_cmp_ge_u32 s47, 4096
    s_cbranch_scc1 L_bkH24
    buffer_load_dwordx4 v[176:179], v2, s[20:23], s43 offen sc1
    buffer_load_dwordx4 v[180:183], v2, s[20:23], s44 offen sc1
    buffer_load_dwordx4 v[184:187], v2, s[20:23], s0 offen sc1
    buffer_load_dwordx4 v[188:191], v2, s[20:23], s1 offen sc1
    s_waitcnt vmcnt(0)
    v_perm_b32 v235, v179, v176, s36
    v_and_b32 v235, 0x101, v235
    v_and_b32 v176, -2, v176
    v_cmp_ne_u32 vcc, s37, v235
    v_and_b32 v179, -2, v179
    s_nop 1
    s_cbranch_vccnz L_rtH24
    s_branch L_bkH24
L_rtH25:
    s_add_u32 s47, s47, 1
    s_cmp_ge_u32 s47, 4096
    s_cbranch_scc1 L_bkH25
    buffer_load_dwordx4 v[180:183], v2, s[20:23], s44 offen sc1
    buffer_load_dwordx4 v[184:187], v2, s[20:23], s0 offen sc1
    buffer_load_dwordx4 v[188:191], v2, s[20:23], s1 offen sc1
    s_waitcnt vmcnt(0)
    v_perm_b32 v235, v183, v180, s36
    v_and_b32 v235, 0x101, v235
    v_and_b32 v180, -2, v180
    v_cmp_ne_u32 vcc, s37, v235
    v_and_b32 v183, -2, v183
    s_nop 1
    s_cbranch_vccnz L_rtH25
    s_branch L_bkH25
L_rtH26:
    s_add_u32 s47, s47, 1
    s_cmp_ge_u32 s47, 4096
    s_cbranch_scc1 L_bkH26
    buffer_load_dwordx4 v[184:187], v2, s[20:23], s0 offen sc1
    buffer_load_dwordx4 v[188:191], v2, s[20:23], s1 offen sc1
    s_waitcnt vmcnt(0)
    v_perm_b32 v235, v187, v184, s36
    v_and_b32 v235, 0x101, v235
    v_and_b32 v184, -2, v184
    v_cmp_ne_u32 vcc, s37, v235
    v_and_b32 v187, -2, v187
    s_nop 1
    s_cbranch_vccnz L_rtH26
    s_branch L_bkH26
L_rtH27:
    s_add_u32 s47, s47, 1
    s_cmp_ge_u32 s47, 4096
    s_cbranch_scc1 L_bkH27
    buffer_load_dwordx4 v[188:191], v2, s[20:23], s1 offen sc1
    s_waitcnt vmcnt(0)
    v_perm_b32 v235, v191, v188, s36
    v_and_b32 v235, 0x101, v235
    v_and_b32 v188, -2, v188
    v_cmp_ne_u32 vcc, s37, v235
    v_and_b32 v191, -2, v191
    s_nop 1
    s_cbranch_vccnz L_rtH27
    s_branch L_bkH27
L_ln:
    s_cmp_lg_u32 s2, 0
    s_cbranch_scc1 L_noinit
    s_cmp_lg_u32 s3, 0
    s_cbranch_scc1 L_noinit
    s_mov_b32 s61, 12599296
    buffer_load_dword v4, off, s[20:23], s61 sc1
    v_lshlrev_b32 v2, 8, v1
    v_mov_b32 v3, 0
    s_mov_b32 s60, 12582912
    buffer_store_dword v3, v2, s[20:23], s60 offen sc1
    s_waitcnt vmcnt(0)
    s_mov_b64 exec, 1
    v_mov_b32 v3, 0x9e3779b1
    v_mul_lo_u32 v3, v3, v4
    v_add_u32 v3, 0x7f4a7c15, v3
    v_not_b32 v4, v4
    v_bfi_b32 v3, 2, v4, v3
    v_or_b32 v3, 1, v3
    buffer_store_dword v3, off, s[28:31], 0 sc1
    buffer_store_dword v3, off, s[20:23], s61 sc1
    s_mov_b64 exec, -1
    s_waitcnt vmcnt(0)
L_noinit:
    v_lshrrev_b32 v2, 3, v1
    s_lshl_b32 s60, s3, 3
    v_add_u32 v2, s60, v2
    s_lshl_b32 s61, s2, 6
    v_add_u32 v3, s61, v2
    v_mul_u32_u24 v3, 896, v3
    v_and_b32 v4, 7, v1
    v_lshl_add_u32 v3, v4, 4, v3
    buffer_load_dwordx4 v[16:19], v3, s[8:11], 0 offen offset:0
    buffer_load_dwordx4 v[20:23], v3, s[8:11], 0 offen offset:128
    buffer_load_dwordx4 v[24:27], v3, s[8:11], 0 offen offset:256
    buffer_load_dwordx4 v[28:31], v3, s[8:11], 0 offen offset:384
    buffer_load_dwordx4 v[32:35], v3, s[8:11], 0 offen offset:512
    buffer_load_dwordx4 v[36:39], v3, s[8:11], 0 offen offset:640
    buffer_load_dwordx4 v[40:43], v3, s[8:11], 0 offen offset:768
    v_sub_u32 v5, 63, v2
    v_mul_u32_u24 v5, 960, v5
    v_lshl_add_u32 v5, v4, 4, v5
    v_bfe_u32 v6, v1, 2, 2
    v_add_u32 v6, s60, v6
    v_mul_u32_u24 v6, 960, v6
    v_lshrrev_b32 v7, 4, v1
    v_lshl_add_u32 v6, v7, 5, v6
    v_and_b32 v7, 3, v1
    v_lshl_add_u32 v6, v7, 3, v6
    v_mul_u32_u24 v7, 144, v1
    s_lshl_b32 s60, s3, 4
    s_add_u32 s60, s60, 61440
    v_add_u32 v7, s60, v7
    v_lshrrev_b32 v8, 3, v0
    v_mul_u32_u24 v9, 144, v8
    v_lshl_add_u32 v9, v4, 4, v9
    v_add_u32 v9, 61440, v9
    v_lshlrev_b32 v8, 12, v8
    v_lshl_add_u32 v8, v4, 4, v8
    v_mov_b32 v10, 0
    v_mov_b32 v11, 0
    v_mov_b32 v12, 0
    v_mov_b32 v13, 0
    s_mov_b32 s62, 0xffff0000
    s_waitcnt vmcnt(6)
    v_lshlrev_b32 v48, 16, v16
    v_and_b32 v49, s62, v16
    v_add_f32 v10, v10, v48
    v_add_f32 v11, v11, v49
    v_fmac_f32 v12, v48, v48
    v_fmac_f32 v13, v49, v49
    v_lshlrev_b32 v50, 16, v17
    v_and_b32 v51, s62, v17
    v_add_f32 v10, v10, v50
    v_add_f32 v11, v11, v51
    v_fmac_f32 v12, v50, v50
    v_fmac_f32 v13, v51, v51
    v_lshlrev_b32 v52, 16, v18
    v_and_b32 v53, s62, v18
    v_add_f32 v10, v10, v52
    v_add_f32 v11, v11, v53
    v_fmac_f32 v12, v52, v52
    v_fmac_f32 v13, v53, v53
    v_lshlrev_b32 v54, 16, v19
    v_and_b32 v55, s62, v19
    v_add_f32 v10, v10, v54
    v_add_f32 v11, v11, v55
    v_fmac_f32 v12, v54, v54
    v_fmac_f32 v13, v55, v55
    s_waitcnt vmcnt(5)
    v_lshlrev_b32 v56, 16, v20
    v_and_b32 v57, s62, v20
    v_add_f32 v10, v10, v56
    v_add_f32 v11, v11, v57
    v_fmac_f32 v12, v56, v56
    v_fmac_f32 v13, v57, v57
    v_lshlrev_b32 v58, 16, v21
    v_and_b32 v59, s62, v21
    v_add_f32 v10, v10, v58
    v_add_f32 v11, v11, v59
    v_fmac_f32 v12, v58, v58
    v_fmac_f32 v13, v59, v59
    v_lshlrev_b32 v60, 16, v22
    v_and_b32 v61, s62, v22
    v_add_f32 v10, v10, v60
    v_add_f32 v11, v11, v61
    v_fmac_f32 v12, v60, v60
    v_fmac_f32 v13, v61, v61
    v_lshlrev_b32 v62, 16, v23
    v_and_b32 v63, s62, v23
    v_add_f32 v10, v10, v62
    v_add_f32 v11, v11, v63
    v_fmac_f32 v12, v62, v62
    v_fmac_f32 v13, v63, v63
    s_waitcnt vmcnt(4)
    v_lshlrev_b32 v64, 16, v24
    v_and_b32 v65, s62, v24
    v_add_f32 v10, v10, v64
    v_add_f32 v11, v11, v65
    v_fmac_f32 v12, v64, v64
    v_fmac_f32 v13, v65, v65
    v_lshlrev_b32 v66, 16, v25
    v_and_b32 v67, s62, v25
    v_add_f32 v10, v10, v66
    v_add_f32 v11, v11, v67
    v_fmac_f32 v12, v66, v66
    v_fmac_f32 v13, v67, v67
    v_lshlrev_b32 v68, 16, v26
    v_and_b32 v69, s62, v26
    v_add_f32 v10, v10, v68
    v_add_f32 v11, v11, v69
    v_fmac_f32 v12, v68, v68
    v_fmac_f32 v13, v69, v69
    v_lshlrev_b32 v70, 16, v27
    v_and_b32 v71, s62, v27
    v_add_f32 v10, v10, v70
    v_add_f32 v11, v11, v71
    v_fmac_f32 v12, v70, v70
    v_fmac_f32 v13, v71, v71
    s_waitcnt vmcnt(3)
    v_lshlrev_b32 v72, 16, v28
    v_and_b32 v73, s62, v28
    v_add_f32 v10, v10, v72
    v_add_f32 v11, v11, v73
    v_fmac_f32 v12, v72, v72
    v_fmac_f32 v13, v73, v73
    v_lshlrev_b32 v74, 16, v29
    v_and_b32 v75, s62, v29
    v_add_f32 v10, v10, v74
    v_add_f32 v11, v11, v75
    v_fmac_f32 v12, v74, v74
    v_fmac_f32 v13, v75, v75
    v_lshlrev_b32 v76, 16, v30
    v_and_b32 v77, s62, v30
    v_add_f32 v10, v10, v76
    v_add_f32 v11, v11, v77
    v_fmac_f32 v12, v76, v76
    v_fmac_f32 v13, v77, v77
    v_lshlrev_b32 v78, 16, v31
    v_and_b32 v79, s62, v31
    v_add_f32 v10, v10, v78
    v_add_f32 v11, v11, v79
    v_fmac_f32 v12, v78, v78
    v_fmac_f32 v13, v79, v79
    s_waitcnt vmcnt(2)
    v_lshlrev_b32 v80, 16, v32
    v_and_b32 v81, s62, v32
    v_add_f32 v10, v10, v80
    v_add_f32 v11, v11, v81
    v_fmac_f32 v12, v80, v80
    v_fmac_f32 v13, v81, v81
    v_lshlrev_b32 v82, 16, v33
    v_and_b32 v83, s62, v33
    v_add_f32 v10, v10, v82
    v_add_f32 v11, v11, v83
    v_fmac_f32 v12, v82, v82
    v_fmac_f32 v13, v83, v83
    v_lshlrev_b32 v84, 16, v34
    v_and_b32 v85, s62, v34
    v_add_f32 v10, v10, v84
    v_add_f32 v11, v11, v85
    v_fmac_f32 v12, v84, v84
    v_fmac_f32 v13, v85, v85
    v_lshlrev_b32 v86, 16, v35
    v_and_b32 v87, s62, v35
    v_add_f32 v10, v10, v86
    v_add_f32 v11, v11, v87
    v_fmac_f32 v12, v86, v86
    v_fmac_f32 v13, v87, v87
    s_waitcnt vmcnt(1)
    v_lshlrev_b32 v88, 16, v36
    v_and_b32 v89, s62, v36
    v_add_f32 v10, v10, v88
    v_add_f32 v11, v11, v89
    v_fmac_f32 v12, v88, v88
    v_fmac_f32 v13, v89, v89
    v_lshlrev_b32 v90, 16, v37
    v_and_b32 v91, s62, v37
    v_add_f32 v10, v10, v90
    v_add_f32 v11, v11, v91
    v_fmac_f32 v12, v90, v90
    v_fmac_f32 v13, v91, v91
    v_lshlrev_b32 v92, 16, v38
    v_and_b32 v93, s62, v38
    v_add_f32 v10, v10, v92
    v_add_f32 v11, v11, v93
    v_fmac_f32 v12, v92, v92
    v_fmac_f32 v13, v93, v93
    v_lshlrev_b32 v94, 16, v39
    v_and_b32 v95, s62, v39
    v_add_f32 v10, v10, v94
    v_add_f32 v11, v11, v95
    v_fmac_f32 v12, v94, v94
    v_fmac_f32 v13, v95, v95
    s_waitcnt vmcnt(0)
    v_lshlrev_b32 v96, 16, v40
    v_and_b32 v97, s62, v40
    v_add_f32 v10, v10, v96
    v_add_f32 v11, v11, v97
    v_fmac_f32 v12, v96, v96
    v_fmac_f32 v13, v97, v97
    v_lshlrev_b32 v98, 16, v41
    v_and_b32 v99, s62, v41
    v_add_f32 v10, v10, v98
    v_add_f32 v11, v11, v99
    v_fmac_f32 v12, v98, v98
    v_fmac_f32 v13, v99, v99
    v_lshlrev_b32 v100, 16, v42
    v_and_b32 v101, s62, v42
    v_add_f32 v10, v10, v100
    v_add_f32 v11, v11, v101
    v_fmac_f32 v12, v100, v100
    v_fmac_f32 v13, v101, v101
    v_lshlrev_b32 v102, 16, v43
    v_and_b32 v103, s62, v43
    v_add_f32 v10, v10, v102
    v_add_f32 v11, v11, v103
    v_fmac_f32 v12, v102, v102
    v_fmac_f32 v13, v103, v103
    v_add_f32 v10, v10, v11
    v_add_f32 v12, v12, v13
    s_nop 0
    v_add_f32_dpp v10, v10, v10 quad_perm:[1,0,3,2] row_mask:0xf bank_mask:0xf
    v_add_f32_dpp v12, v12, v12 quad_perm:[1,0,3,2] row_mask:0xf bank_mask:0xf
    s_nop 0
    v_add_f32_dpp v10, v10, v10 quad_perm:[2,3,0,1] row_mask:0xf bank_mask:0xf
    v_add_f32_dpp v12, v12, v12 quad_perm:[2,3,0,1] row_mask:0xf bank_mask:0xf
    s_nop 0
    v_add_f32_dpp v10, v10, v10 row_half_mirror row_mask:0xf bank_mask:0xf
    v_add_f32_dpp v12, v12, v12 row_half_mirror row_mask:0xf bank_mask:0xf
    v_mul_f32 v10, 0x3b124925, v10
    v_mul_f32 v12, 0x3b124925, v12
    v_fma_f32 v12, -v10, v10, v12
    v_max_f32 v12, 0, v12
    v_cvt_pk_bf16_f32 v12, v12, v12
    v_lshlrev_b32 v12, 16, v12
    v_add_f32 v12, 0x3727c5ac, v12
    v_cvt_pk_bf16_f32 v12, v12, v12
    v_lshlrev_b32 v12, 16, v12
    v_sqrt_f32 v12, v12
    s_nop 0
    v_cvt_pk_bf16_f32 v12, v12, v12
    v_lshlrev_b32 v12, 16, v12
    v_rcp_f32 v12, v12
    v_cvt_pk_bf16_f32 v10, v10, v10
    v_lshlrev_b32 v10, 16, v10
    v_mul_f32 v10, v10, v12
    v_sub_f32 v10, 0, v10
    v_fma_f32 v48, v48, v12, v10
    v_fma_f32 v49, v49, v12, v10
    v_cvt_pk_bf16_f32 v16, v48, v49
    v_fma_f32 v50, v50, v12, v10
    v_fma_f32 v51, v51, v12, v10
    v_cvt_pk_bf16_f32 v17, v50, v51
    v_fma_f32 v52, v52, v12, v10
    v_fma_f32 v53, v53, v12, v10
    v_cvt_pk_bf16_f32 v18, v52, v53
    v_fma_f32 v54, v54, v12, v10
    v_fma_f32 v55, v55, v12, v10
    v_cvt_pk_bf16_f32 v19, v54, v55
    ds_write_b128 v5, v[16:19] offset:0
    v_fma_f32 v56, v56, v12, v10
    v_fma_f32 v57, v57, v12, v10
    v_cvt_pk_bf16_f32 v20, v56, v57
    v_fma_f32 v58, v58, v12, v10
    v_fma_f32 v59, v59, v12, v10
    v_cvt_pk_bf16_f32 v21, v58, v59
    v_fma_f32 v60, v60, v12, v10
    v_fma_f32 v61, v61, v12, v10
    v_cvt_pk_bf16_f32 v22, v60, v61
    v_fma_f32 v62, v62, v12, v10
    v_fma_f32 v63, v63, v12, v10
    v_cvt_pk_bf16_f32 v23, v62, v63
    ds_write_b128 v5, v[20:23] offset:128
    v_fma_f32 v64, v64, v12, v10
    v_fma_f32 v65, v65, v12, v10
    v_cvt_pk_bf16_f32 v24, v64, v65
    v_fma_f32 v66, v66, v12, v10
    v_fma_f32 v67, v67, v12, v10
    v_cvt_pk_bf16_f32 v25, v66, v67
    v_fma_f32 v68, v68, v12, v10
    v_fma_f32 v69, v69, v12, v10
    v_cvt_pk_bf16_f32 v26, v68, v69
    v_fma_f32 v70, v70, v12, v10
    v_fma_f32 v71, v71, v12, v10
    v_cvt_pk_bf16_f32 v27, v70, v71
    ds_write_b128 v5, v[24:27] offset:256
    v_fma_f32 v72, v72, v12, v10
    v_fma_f32 v73, v73, v12, v10
    v_cvt_pk_bf16_f32 v28, v72, v73
    v_fma_f32 v74, v74, v12, v10
    v_fma_f32 v75, v75, v12, v10
    v_cvt_pk_bf16_f32 v29, v74, v75
    v_fma_f32 v76, v76, v12, v10
    v_fma_f32 v77, v77, v12, v10
    v_cvt_pk_bf16_f32 v30, v76, v77
    v_fma_f32 v78, v78, v12, v10
    v_fma_f32 v79, v79, v12, v10
    v_cvt_pk_bf16_f32 v31, v78, v79
    ds_write_b128 v5, v[28:31] offset:384
    v_fma_f32 v80, v80, v12, v10
    v_fma_f32 v81, v81, v12, v10
    v_cvt_pk_bf16_f32 v32, v80, v81
    v_fma_f32 v82, v82, v12, v10
    v_fma_f32 v83, v83, v12, v10
    v_cvt_pk_bf16_f32 v33, v82, v83
    v_fma_f32 v84, v84, v12, v10
    v_fma_f32 v85, v85, v12, v10
    v_cvt_pk_bf16_f32 v34, v84, v85
    v_fma_f32 v86, v86, v12, v10
    v_fma_f32 v87, v87, v12, v10
    v_cvt_pk_bf16_f32 v35, v86, v87
    ds_write_b128 v5, v[32:35] offset:512
    v_fma_f32 v88, v88, v12, v10
    v_fma_f32 v89, v89, v12, v10
    v_cvt_pk_bf16_f32 v36, v88, v89
    v_fma_f32 v90, v90, v12, v10
    v_fma_f32 v91, v91, v12, v10
    v_cvt_pk_bf16_f32 v37, v90, v91
    v_fma_f32 v92, v92, v12, v10
    v_fma_f32 v93, v93, v12, v10
    v_cvt_pk_bf16_f32 v38, v92, v93
    v_fma_f32 v94, v94, v12, v10
    v_fma_f32 v95, v95, v12, v10
    v_cvt_pk_bf16_f32 v39, v94, v95
    ds_write_b128 v5, v[36:39] offset:640
    v_fma_f32 v96, v96, v12, v10
    v_fma_f32 v97, v97, v12, v10
    v_cvt_pk_bf16_f32 v40, v96, v97
    v_fma_f32 v98, v98, v12, v10
    v_fma_f32 v99, v99, v12, v10
    v_cvt_pk_bf16_f32 v41, v98, v99
    v_fma_f32 v100, v100, v12, v10
    v_fma_f32 v101, v101, v12, v10
    v_cvt_pk_bf16_f32 v42, v100, v101
    v_fma_f32 v102, v102, v12, v10
    v_fma_f32 v103, v103, v12, v10
    v_cvt_pk_bf16_f32 v43, v102, v103
    ds_write_b128 v5, v[40:43] offset:768
    s_waitcnt lgkmcnt(0)
    s_barrier
    ds_read_b64_tr_b16 v[16:17], v6 offset:0
    ds_read_b64_tr_b16 v[18:19], v6 offset:3840
    ds_read_b64_tr_b16 v[20:21], v6 offset:128
    ds_read_b64_tr_b16 v[22:23], v6 offset:3968
    ds_read_b64_tr_b16 v[24:25], v6 offset:256
    ds_read_b64_tr_b16 v[26:27], v6 offset:4096
    ds_read_b64_tr_b16 v[28:29], v6 offset:384
    ds_read_b64_tr_b16 v[30:31], v6 offset:4224
    ds_read_b64_tr_b16 v[32:33], v6 offset:512
    ds_read_b64_tr_b16 v[34:35], v6 offset:4352
    ds_read_b64_tr_b16 v[36:37], v6 offset:640
    ds_read_b64_tr_b16 v[38:39], v6 offset:4480
    ds_read_b64_tr_b16 v[40:41], v6 offset:768
    ds_read_b64_tr_b16 v[42:43], v6 offset:4608
    s_waitcnt lgkmcnt(12)
    ds_write_b128 v7, v[16:19] offset:0
    s_waitcnt lgkmcnt(11)
    ds_write_b128 v7, v[20:23] offset:9216
    s_waitcnt lgkmcnt(10)
    ds_write_b128 v7, v[24:27] offset:18432
    s_waitcnt lgkmcnt(9)
    ds_write_b128 v7, v[28:31] offset:27648
    s_waitcnt lgkmcnt(8)
    ds_write_b128 v7, v[32:35] offset:36864
    s_waitcnt lgkmcnt(7)
    ds_write_b128 v7, v[36:39] offset:46080
    s_waitcnt lgkmcnt(6)
    ds_write_b128 v7, v[40:43] offset:55296
    s_waitcnt lgkmcnt(0)
    s_barrier
    ds_read_b128 v[16:19], v9 offset:0
    ds_read_b128 v[20:23], v9 offset:9216
    ds_read_b128 v[24:27], v9 offset:18432
    ds_read_b128 v[28:31], v9 offset:27648
    ds_read_b128 v[32:35], v9 offset:36864
    ds_read_b128 v[36:39], v9 offset:46080
    ds_read_b128 v[40:43], v9 offset:55296
    s_lshl_b32 s60, s2, 7
    s_sub_u32 s60, 8392576, s60
    s_waitcnt lgkmcnt(6)
    buffer_store_dwordx4 v[16:19], v8, s[20:23], s60 offen sc1
    s_add_u32 s60, s60, 262144
    s_waitcnt lgkmcnt(5)
    buffer_store_dwordx4 v[20:23], v8, s[20:23], s60 offen sc1
    s_add_u32 s60, s60, 262144
    s_waitcnt lgkmcnt(4)
    buffer_store_dwordx4 v[24:27], v8, s[20:23], s60 offen sc1
    s_add_u32 s60, s60, 262144
    s_waitcnt lgkmcnt(3)
    buffer_store_dwordx4 v[28:31], v8, s[20:23], s60 offen sc1
    s_add_u32 s60, s60, 262144
    s_waitcnt lgkmcnt(2)
    buffer_store_dwordx4 v[32:35], v8, s[20:23], s60 offen sc1
    s_add_u32 s60, s60, 262144
    s_waitcnt lgkmcnt(1)
    buffer_store_dwordx4 v[36:39], v8, s[20:23], s60 offen sc1
    s_add_u32 s60, s60, 262144
    s_waitcnt lgkmcnt(0)
    buffer_store_dwordx4 v[40:43], v8, s[20:23], s60 offen sc1
    s_waitcnt vmcnt(0)
    s_barrier
    s_cmp_lg_u32 s3, 0
    s_cbranch_scc1 L_end_F
    buffer_load_dword v2, off, s[28:31], 0 sc1
    s_waitcnt vmcnt(0)
    v_readfirstlane_b32 s62, v2
    s_nop 0
    s_cmp_ge_u32 s62, 1
    s_cbranch_scc1 L_pd_i0
    s_mov_b32 s63, 0
L_pl_i0:
    buffer_load_dword v2, off, s[28:31], 0 sc1
    s_waitcnt vmcnt(0)
    v_readfirstlane_b32 s62, v2
    s_nop 0
    s_cmp_ge_u32 s62, 1
    s_cbranch_scc1 L_pd_i0
    s_add_u32 s63, s63, 1
    s_cmp_lt_u32 s63, 20000
    s_cbranch_scc1 L_pl_i0
L_pd_i0:
    s_mov_b64 exec, 1
    v_mov_b32 v2, 0
    v_mov_b32 v3, 1
    s_mov_b32 s60, 12582912
    buffer_atomic_add v3, v2, s[20:23], s60 offen sc1
L_end_F:
    s_endpgm
.section .rodata,"a"
.p2align 6
.amdhsa_kernel recurrent_scan__ssm_conv_s4__mixer_channel_mlp__prompt_kernel
  .amdhsa_next_free_vgpr 256
  .amdhsa_next_free_sgpr 102
  .amdhsa_accum_offset 256
  .amdhsa_group_segment_fixed_size 0
  .amdhsa_kernarg_size 136
  .amdhsa_user_sgpr_count 2
  .amdhsa_user_sgpr_kernarg_segment_ptr 1
  .amdhsa_system_sgpr_workgroup_id_x 1
.end_amdhsa_kernel
```
